```python
import torch

def _softmax(x, axis=-1):
    return torch.softmax(x, dim=axis)
def _gelu(x):
    return torch.nn.functional.gelu(x, approximate="tanh")
def _silu(x):
    return torch.nn.functional.silu(x)
def _sigmoid(x):
    return torch.sigmoid(x)
def _layernorm(x, axis=-1, eps=1e-5):
    m = x.mean(dim=axis, keepdim=True)
    v = x.var(dim=axis, keepdim=True, unbiased=False)
    return (x - m) / torch.sqrt(v + eps)
def _scatter_add(tgt, idx, src, axis=0):
    return tgt.clone().index_add_(axis, idx, src)
def _segment_sum(src, seg, n):
    out = torch.zeros((n,) + src.shape[1:], dtype=src.dtype)
    return out.index_add_(0, seg, src)
def _pad(x, pw):
    flat = tuple(v for pair in reversed(pw) for v in pair)
    return torch.nn.functional.pad(x, flat)

kernel_name = 'standalone__gqa_block_cached__near_ridge'

def setup_inputs():

    _w = (lambda a: (lambda t: t.to(torch.bfloat16) if t.is_floating_point() else t)(torch.as_tensor(a)))
    B, Sq, D = 16, 80, 576
    Hq, Hkv, Sk, Dh = 32, 16, 512, 128
    assert Hq % Hkv == 0, (Hq, Hkv)
    return {
        "x": _w((lambda *s: torch.randn(*s, dtype=torch.bfloat16) * 0.8)(B, Sq, D)),
        "k_cache": _w((lambda *s: torch.randn(*s, dtype=torch.bfloat16) * 0.8)(B, Hkv, Sk, Dh)),
        "v_cache": _w((lambda *s: torch.randn(*s, dtype=torch.bfloat16) * 0.05)(B, Hkv, Sk, Dh)),
        "wq": _w((lambda *s: torch.randn(*s, dtype=torch.bfloat16) * 0.8)(D, Hq * Dh) * (D ** -0.5)),
        "wo": _w((lambda *s: torch.randn(*s, dtype=torch.bfloat16) * 0.05)(Hq * Dh, D) * ((Hq * Dh) ** -0.5)),
    }

def reference(x, k_cache, v_cache, wq, wo):
    B, Sq, D = x.shape
    Hq, Dh = 32, 128
    Hkv = k_cache.shape[1]
    rep = Hq // Hkv
    q = (lambda x, *d: x.permute(*d))((x @ wq).reshape(B, Sq, Hq, Dh), 0, 2, 1, 3)
    k = (lambda x, n, axis: torch.repeat_interleave(x, n, dim=axis))(k_cache, rep, axis=1)
    v = (lambda x, n, axis: torch.repeat_interleave(x, n, dim=axis))(v_cache, rep, axis=1)
    scores = torch.einsum("bhqd,bhkd->bhqk", q, k) * (Dh ** -0.5)
    p = _softmax(scores, axis=-1)
    o = torch.einsum("bhqk,bhkd->bhqd", p, v)
    return (lambda x, *d: x.permute(*d))(o, 0, 2, 1, 3).reshape(B, Sq, Hq * Dh) @ wo
```

```asm
; @launch grid=(256,1,1) block=(256,1,1) lds=163840
.amdgcn_target "amdgcn-amd-amdhsa--gfx950"
.text
.globl standalone__gqa_block_cached__near_ridge_kernel
.p2align 8
.type standalone__gqa_block_cached__near_ridge_kernel,@function
standalone__gqa_block_cached__near_ridge_kernel:
    s_cmp_ge_u32 s2, 256
    s_cbranch_scc1 L_end
    s_load_dwordx2 s[32:33], s[0:1], 24
    s_load_dwordx2 s[20:21], s[0:1], 0
    s_lshr_b32 s47, s2, 3
    s_getpc_b64 s[64:65]
    s_mul_i32 s48, s47, 1280
    v_lshl_add_u32 v26, v0, 3, s48
    global_load_dword v255, v26, s[64:65]
    v_lshrrev_b32 v24, 6, v0
    s_and_b32 s46, s2, 7
    v_readfirstlane_b32 s3, v24
    s_and_b32 s48, s47, 1
    s_lshl_b32 s46, s46, 1
    s_or_b32 s45, s46, s48
    s_lshr_b32 s44, s47, 1
    s_cmp_ge_u32 s44, 9
    s_cselect_b32 s47, 1, 0
    s_cselect_b32 s46, 9, 0
    s_sub_u32 s10, s44, s46
    s_lshl2_add_u32 s9, s48, s10
    s_cmp_ge_u32 s9, 9
    s_cselect_b32 s46, 9, 0
    s_sub_u32 s9, s9, s46
    s_and_b32 s46, s2, 7
    s_lshl_b32 s46, s46, 0
    s_add_u32 s9, s9, s46
    s_cmp_ge_u32 s9, 9
    s_cselect_b32 s46, 9, 0
    s_sub_u32 s9, s9, s46
    s_lshl_b32 s11, s45, 9
    s_lshl_b32 s46, s47, 18
    s_add_u32 s11, s11, s46
    s_lshl_b32 s46, s9, 19
    s_add_u32 s48, s46, s11
    s_xor_b32 s49, s48, 0x40000
    s_mul_i32 s89, s3, 4224
    s_mul_i32 s90, s3, 5120
    s_lshr_b32 s4, s3, 1
    s_and_b32 s46, s3, 1
    s_mul_i32 s8, s44, 92160
    s_lshl_b32 s5, s9, 7
    s_add_u32 s66, s5, s8
    s_mul_i32 s5, s4, 18432
    s_add_u32 s70, s66, s5
    s_mul_i32 s91, s46, 5120
    s_lshl_b32 s5, s4, 11
    s_add_u32 s91, s91, s5
    s_mov_b32 s34, 4718592
    s_mov_b32 s35, 0x20000
    s_mov_b32 s22, 1474560
    s_mov_b32 s23, 0x20000
    s_mov_b32 s94, 0
L_restart:
    s_lshr_b32 s4, s3, 1
    v_and_b32 v25, 63, v0
    v_lshrrev_b32 v24, 5, v25
    v_lshlrev_b32 v24, 17, v24
    v_and_b32 v26, 31, v25
    v_lshl_add_u32 v24, v26, 4, v24
    s_lshl_b32 s5, s46, 16
    s_lshl_b32 s6, s4, 15
    s_add_u32 s5, s5, s6
    v_add_u32 v112, s5, v24
    v_add_u32 v113, 7136, v112
    v_add_u32 v114, 14272, v112
    v_add_u32 v115, 21408, v112
    v_lshrrev_b32 v24, 3, v25
    v_mul_u32_u24 v24, 1152, v24
    v_lshrrev_b32 v26, 4, v25
    s_lshl_b32 s5, s46, 2
    v_or_b32 v26, s5, v26
    v_and_b32 v27, 7, v25
    v_xor_b32 v26, v26, v27
    v_lshl_add_u32 v26, v26, 4, v24
    s_mul_i32 s5, s46, 46080
    v_add_u32 v116, s5, v26
    v_xor_b32 v27, 64, v116
    v_add_u32 v117, 8192, v27
    v_add_u32 v118, 16384, v116
    v_add_u32 v119, 24576, v27
    v_add_u32 v120, 36864, v116
    s_waitcnt lgkmcnt(0)
    s_add_u32 m0, s91, 96768
    s_nop 0
    buffer_load_dwordx4 v116, s[20:23], s70 offen lds
    buffer_load_dwordx4 v117, s[20:23], s70 offen offset:1024 lds
    buffer_load_dwordx4 v118, s[20:23], s70 offen offset:2048 lds
    s_add_u32 m0, s89, 0
    s_nop 0
    buffer_load_dwordx4 v112, s[32:35], s48 offen lds
    buffer_load_dwordx4 v113, s[32:35], s48 offen offset:1056 lds
    buffer_load_dwordx4 v114, s[32:35], s48 offen offset:2112 lds
    buffer_load_dwordx4 v115, s[32:35], s48 offen offset:3168 lds
    s_add_u32 m0, s89, 16896
    s_nop 0
    buffer_load_dwordx4 v112, s[32:35], s49 offen lds
    buffer_load_dwordx4 v113, s[32:35], s49 offen offset:1056 lds
    buffer_load_dwordx4 v114, s[32:35], s49 offen offset:2112 lds
    buffer_load_dwordx4 v115, s[32:35], s49 offen offset:3168 lds
    s_cmp_lg_u32 s94, 0
    s_cbranch_scc1 L_known
    s_load_dwordx2 s[24:25], s[0:1], 8
    s_load_dwordx2 s[28:29], s[0:1], 16
    s_load_dwordx2 s[36:37], s[0:1], 32
    s_load_dwordx2 s[40:41], s[0:1], 56
    s_load_dwordx2 s[12:13], s[0:1], 40
    s_load_dwordx2 s[16:17], s[0:1], 48
    s_add_u32 s11, s11, 4718592
    s_add_u32 s7, s8, 1152
    s_lshl_b32 s6, s4, 7
    s_add_u32 s6, s6, 128
    s_add_u32 s66, s66, s6
    s_cmp_ge_u32 s66, s7
    s_cselect_b32 s5, 1152, 0
    s_sub_u32 s66, s66, s5
    s_add_u32 s50, s48, 524288
    s_cmp_ge_u32 s50, s11
    s_cselect_b32 s5, 4718592, 0
    s_sub_u32 s50, s50, s5
    s_add_u32 s67, s66, 256
    s_cmp_ge_u32 s67, s7
    s_cselect_b32 s5, 1152, 0
    s_sub_u32 s67, s67, s5
L_known:
    s_cmp_lg_u32 s94, 0
    s_cbranch_scc1 L_known2
    s_xor_b32 s51, s50, 0x40000
    s_add_u32 s52, s50, 524288
    s_cmp_ge_u32 s52, s11
    s_cselect_b32 s5, 4718592, 0
    s_sub_u32 s52, s52, s5
    s_xor_b32 s53, s52, 0x40000
    s_add_u32 s54, s52, 524288
    s_cmp_ge_u32 s54, s11
    s_cselect_b32 s5, 4718592, 0
    s_sub_u32 s54, s54, s5
    s_xor_b32 s55, s54, 0x40000
    s_add_u32 s56, s54, 524288
    s_cmp_ge_u32 s56, s11
    s_cselect_b32 s5, 4718592, 0
    s_sub_u32 s56, s56, s5
    s_xor_b32 s57, s56, 0x40000
    s_add_u32 s58, s56, 524288
    s_cmp_ge_u32 s58, s11
    s_cselect_b32 s5, 4718592, 0
    s_sub_u32 s58, s58, s5
    s_xor_b32 s59, s58, 0x40000
    s_add_u32 s60, s58, 524288
    s_cmp_ge_u32 s60, s11
    s_cselect_b32 s5, 4718592, 0
    s_sub_u32 s60, s60, s5
    s_xor_b32 s61, s60, 0x40000
    s_add_u32 s62, s60, 524288
    s_cmp_ge_u32 s62, s11
    s_cselect_b32 s5, 4718592, 0
    s_sub_u32 s62, s62, s5
    s_xor_b32 s63, s62, 0x40000
    s_add_u32 s64, s62, 524288
    s_cmp_ge_u32 s64, s11
    s_cselect_b32 s5, 4718592, 0
    s_sub_u32 s64, s64, s5
    s_xor_b32 s65, s64, 0x40000
    s_add_u32 s68, s67, 256
    s_cmp_ge_u32 s68, s7
    s_cselect_b32 s5, 1152, 0
    s_sub_u32 s68, s68, s5
    s_add_u32 s69, s68, 256
    s_cmp_ge_u32 s69, s7
    s_cselect_b32 s5, 1152, 0
    s_sub_u32 s69, s69, s5
    s_mul_i32 s7, s45, 294912
    s_lshl_b32 s6, s10, 7
    s_add_u32 s6, s6, s7
    s_add_u32 s7, s7, 1152
    s_add_u32 s75, s6, 1024
    s_cmp_ge_u32 s75, s7
    s_cselect_b32 s5, 1152, 0
    s_sub_u32 s75, s75, s5
    s_and_b32 s8, s45, 1
    s_lshl_b32 s9, s8, 9
    s_add_u32 s76, s6, s9
    s_cmp_ge_u32 s76, s7
    s_cselect_b32 s5, 1152, 0
    s_sub_u32 s76, s76, s5
    s_xor_b32 s9, s9, 512
    s_add_u32 s71, s6, s9
    s_cmp_ge_u32 s71, s7
    s_cselect_b32 s5, 1152, 0
    s_sub_u32 s71, s71, s5
    s_add_u32 s72, s71, 128
    s_cmp_ge_u32 s72, s7
    s_cselect_b32 s5, 1152, 0
    s_sub_u32 s72, s72, s5
    s_add_u32 s73, s72, 128
    s_cmp_ge_u32 s73, s7
    s_cselect_b32 s5, 1152, 0
    s_sub_u32 s73, s73, s5
    s_add_u32 s74, s73, 128
    s_cmp_ge_u32 s74, s7
    s_cselect_b32 s5, 1152, 0
    s_sub_u32 s74, s74, s5
    s_add_u32 s77, s76, 128
    s_cmp_ge_u32 s77, s7
    s_cselect_b32 s5, 1152, 0
    s_sub_u32 s77, s77, s5
    s_add_u32 s78, s77, 128
    s_cmp_ge_u32 s78, s7
    s_cselect_b32 s5, 1152, 0
    s_sub_u32 s78, s78, s5
    s_add_u32 s79, s78, 128
    s_cmp_ge_u32 s79, s7
    s_cselect_b32 s5, 1152, 0
    s_sub_u32 s79, s79, s5
    s_lshl_b32 s5, s44, 4
    s_or_b32 s5, s5, s45
    s_lshl_b32 s80, s5, 17
    s_add_u32 s81, s80, 16384
    s_add_u32 s82, s80, 32768
    s_add_u32 s83, s80, 49152
    s_add_u32 s84, s80, 65536
    s_add_u32 s85, s80, 81920
    s_add_u32 s86, s80, 98304
    s_add_u32 s87, s80, 114688
    s_xor_b32 s88, s46, s4
    s_lshl3_add_u32 s88, s4, s88
    s_mul_i32 s88, s88, 1040
    s_lshl_b32 s92, s3, 13
    s_mov_b32 s95, 0x3e0293ee
    s_mov_b32 s26, 33554432
    s_mov_b32 s27, 0x20000
    s_mov_b32 s30, 33554432
    s_mov_b32 s31, 0x20000
    s_mov_b32 s38, 4718592
    s_mov_b32 s39, 0x20000
    s_mov_b32 s42, 268435456
    s_mov_b32 s43, 0x20000
    s_mov_b32 s14, 1474560
    s_mov_b32 s15, 0x20000
    s_mov_b32 s18, 256
    s_mov_b32 s19, 0x20000
    v_mov_b32 v76, 0
    v_mov_b32 v77, 0
    v_mov_b32 v78, 0
    v_mov_b32 v79, 0
    v_mov_b32 v80, 0
    v_mov_b32 v81, 0
    v_mov_b32 v82, 0
    v_mov_b32 v83, 0
    v_mov_b32 v84, 0
    v_mov_b32 v85, 0
    v_mov_b32 v86, 0
    v_mov_b32 v87, 0
    s_waitcnt lgkmcnt(0)
    s_mov_b32 s1, s10
L_known2:
    s_and_b32 s6, s94, 1073741824
    s_bfe_u32 s5, s45, 0x30001
    s_lshl_b32 s5, s5, 10
    s_add_u32 s5, s5, s80
    s_add_u32 s5, s5, 114688
    s_add_u32 s7, s5, 8192
    v_lshl_add_u32 v26, v0, 2, s6
    v_mov_b32 v254, 0
    buffer_store_dword v254, v26, s[40:43], s5 offen sc1
    buffer_store_dword v254, v26, s[40:43], s7 offen sc1
    s_nop 1
    v_lshrrev_b32 v26, 4, v25
    v_and_b32 v27, 15, v25
    v_lshlrev_b32 v27, 4, v27
    v_lshl_add_u32 v9, v26, 12, v27
    s_lshl_b32 s5, s3, 10
    v_add_u32 v9, s5, v9
    v_lshl_add_u32 v10, v26, 11, v27
    s_lshl_b32 s5, s46, 10
    s_lshl_b32 s6, s4, 13
    s_add_u32 s5, s5, s6
    v_add_u32 v10, s5, v10
    v_bfe_u32 v27, v25, 1, 2
    v_xor_b32 v27, v27, v26
    v_lshlrev_b32 v27, 5, v27
    v_and_b32 v11, 1, v25
    v_lshl_add_u32 v11, v11, 4, v27
    v_add_u32 v11, v11, v24
    s_mul_i32 s5, s3, 73728
    v_add_u32 v11, s5, v11
    v_bfe_u32 v24, v25, 2, 2
    v_bfe_u32 v26, v25, 4, 1
    v_lshrrev_b32 v27, 5, v25
    v_and_b32 v128, 3, v25
    v_lshlrev_b32 v128, 3, v128
    v_and_b32 v129, 15, v25
    v_lshl_add_u32 v130, v26, 2, v24
    v_mul_u32_u24 v131, 1056, v130
    v_add_u32 v131, v131, v128
    s_lshl_b32 s5, s46, 7
    s_xor_b32 s6, s5, 128
    v_lshl_add_u32 v132, v27, 9, v131
    s_lshl_b32 s7, s4, 8
    s_add_u32 s7, s7, 0
    s_add_u32 s8, s7, s5
    v_add_u32 v121, s8, v132
    s_add_u32 s8, s7, s6
    v_add_u32 v122, s8, v132
    v_lshrrev_b32 v132, 4, v25
    v_bfe_u32 v133, v25, 1, 3
    v_xor_b32 v132, v132, v133
    s_bfe_u32 s7, s48, 0x10012
    s_lshl_b32 s7, s7, 2
    v_xor_b32 v132, s7, v132
    v_lshlrev_b32 v132, 4, v132
    v_lshl_add_u32 v132, v129, 7, v132
    v_add_u32 v125, 55808, v132
    v_xor_b32 v132, 64, v132
    v_add_u32 v126, 55808, v132
    s_mul_i32 s7, s46, 6144
    v_add_u32 v123, s7, v125
    v_add_u32 v124, s7, v126
    v_lshl_add_u32 v132, v27, 8, v131
    s_mul_i32 s7, s46, 8448
    s_sub_u32 s8, 8448, s7
    s_add_u32 s9, s7, s5
    s_add_u32 s9, s9, 130048
    v_add_u32 v5, s9, v132
    s_add_u32 s9, s7, s6
    s_add_u32 s9, s9, 130048
    v_add_u32 v6, s9, v132
    s_add_u32 s9, s8, s5
    s_add_u32 s9, s9, 130048
    v_add_u32 v7, s9, v132
    s_add_u32 s9, s8, s6
    s_add_u32 s9, s9, 130048
    v_add_u32 v8, s9, v132
    v_lshrrev_b32 v132, 1, v24
    v_xor_b32 v133, v132, v24
    v_and_b32 v133, 1, v133
    v_lshl_add_u32 v133, v132, 3, v133
    v_and_b32 v132, 3, v25
    v_lshl_add_u32 v133, v132, 1, v133
    v_mul_u32_u24 v133, 1040, v133
    v_lshl_add_u32 v132, v26, 1, v27
    v_lshl_add_u32 v133, v132, 4, v133
    s_lshl_b32 s7, s46, 9
    s_xor_b32 s8, s7, 512
    s_add_u32 s9, s7, s5
    s_add_u32 s9, s9, 96768
    v_add_u32 v1, s9, v133
    s_add_u32 s9, s7, s6
    s_add_u32 s9, s9, 96768
    v_add_u32 v2, s9, v133
    s_add_u32 s9, s8, s5
    s_add_u32 s9, s9, 96768
    v_add_u32 v3, s9, v133
    s_add_u32 s9, s8, s6
    s_add_u32 s9, s9, 96768
    v_add_u32 v4, s9, v133
    v_lshrrev_b32 v132, 2, v25
    v_bfe_u32 v133, v25, 3, 2
    v_xor_b32 v133, s3, v133
    v_lshlrev_b32 v133, 5, v133
    v_lshl_add_u32 v133, v132, 7, v133
    v_add_u32 v12, v133, v128
    v_add_u32 v13, 65536, v12
    v_add_u32 v22, 131072, v12
    v_mov_b32 v14, 118784
    v_lshlrev_b32 v132, 4, v25
    v_add_u32 v18, 98304, v132
    s_lshl_b32 s7, s4, 12
    s_lshl_b32 s8, s46, 11
    s_add_u32 s9, s7, s8
    v_add_u32 v17, s9, v18
    s_lshl_b32 s10, s46, 13
    s_add_u32 s9, s9, s10
    v_add_u32 v15, s9, v18
    s_xor_b32 s9, s9, 2048
    v_add_u32 v16, s9, v18
    s_mul_i32 s7, s3, 5120
    s_add_u32 s7, s7, 98304
    v_add_u32 v19, s7, v132
    s_xor_b32 s8, s3, 1
    s_mul_i32 s7, s8, 5120
    s_add_u32 s7, s7, 98304
    v_add_u32 v20, s7, v132
    s_lshl_b32 s7, s3, 11
    s_add_u32 s7, s7, 55808
    v_add_u32 v140, s7, v132
    s_lshl_b32 s7, s8, 11
    s_add_u32 s7, s7, 55808
    v_add_u32 v141, s7, v132
    v_lshlrev_b32 v21, 4, v0
    s_lshl_b32 s7, s3, 2
    s_add_u32 s7, s7, 118784
    v_mov_b32 v23, s7
    v_mov_b32 v132, 0x3f803f80
    v_accvgpr_write_b32 a224, v132
    v_accvgpr_write_b32 a225, v132
    v_accvgpr_write_b32 a226, v132
    v_accvgpr_write_b32 a227, v132
    s_add_u32 m0, s90, 55808
    s_nop 0
    buffer_load_dwordx4 v116, s[20:23], s66 offen lds
    buffer_load_dwordx4 v117, s[20:23], s66 offen offset:1024 lds
    buffer_load_dwordx4 v118, s[20:23], s66 offen offset:2048 lds
    buffer_load_dwordx4 v119, s[20:23], s66 offen offset:3072 lds
    s_add_u32 m0, s90, 59904
    s_nop 0
    buffer_load_dwordx4 v120, s[20:23], s66 offen lds
    s_waitcnt vmcnt(11)
    s_barrier
    s_add_u32 m0, s89, 33792
    ds_read_b64_tr_b16 a[0:1], v121 offset:0
    ds_read_b64_tr_b16 a[2:3], v121 offset:8448
    ds_read_b64_tr_b16 a[4:5], v121 offset:32
    ds_read_b64_tr_b16 a[6:7], v121 offset:8480
    ds_read_b64_tr_b16 a[8:9], v121 offset:64
    ds_read_b64_tr_b16 a[10:11], v121 offset:8512
    ds_read_b64_tr_b16 a[12:13], v121 offset:96
    ds_read_b64_tr_b16 a[14:15], v121 offset:8544
    ds_read_b64_tr_b16 a[16:17], v122 offset:0
    ds_read_b64_tr_b16 a[18:19], v122 offset:8448
    ds_read_b64_tr_b16 a[20:21], v122 offset:32
    ds_read_b64_tr_b16 a[22:23], v122 offset:8480
    ds_read_b64_tr_b16 a[24:25], v122 offset:64
    ds_read_b64_tr_b16 a[26:27], v122 offset:8512
    ds_read_b64_tr_b16 a[28:29], v122 offset:96
    ds_read_b64_tr_b16 a[30:31], v122 offset:8544
    s_waitcnt vmcnt(7) lgkmcnt(0)
    s_barrier
    s_lshl_b32 s8, s46, 13
    ds_read_b128 a[64:67], v123 offset:40960
    s_waitcnt lgkmcnt(0)
    v_mfma_f32_16x16x32_bf16 v[148:151], a[0:3], a[64:67], 0
    ds_read_b128 a[68:71], v123 offset:43008
    ds_read_b128 a[72:75], v125 offset:45056
    s_waitcnt lgkmcnt(1)
    v_mfma_f32_16x16x32_bf16 v[180:183], a[0:3], a[68:71], 0
    buffer_load_dwordx4 v112, s[32:35], s50 offen lds
    s_waitcnt lgkmcnt(0)
    v_mfma_f32_16x16x32_bf16 v[212:215], a[0:3], a[72:75], 0
    buffer_load_dwordx4 v113, s[32:35], s50 offen offset:1056 lds
    v_mfma_f32_16x16x32_bf16 v[152:155], a[4:7], a[64:67], 0
    buffer_load_dwordx4 v114, s[32:35], s50 offen offset:2112 lds
    v_mfma_f32_16x16x32_bf16 v[184:187], a[4:7], a[68:71], 0
    buffer_load_dwordx4 v115, s[32:35], s50 offen offset:3168 lds
    s_add_u32 m0, s89, 0
    v_mfma_f32_16x16x32_bf16 v[216:219], a[4:7], a[72:75], 0
    buffer_load_dwordx4 v112, s[32:35], s51 offen lds
    v_mfma_f32_16x16x32_bf16 v[156:159], a[8:11], a[64:67], 0
    buffer_load_dwordx4 v113, s[32:35], s51 offen offset:1056 lds
    ds_read_b128 a[76:79], v124 offset:40960
    v_mfma_f32_16x16x32_bf16 v[188:191], a[8:11], a[68:71], 0
    ds_read_b64_tr_b16 a[32:33], v121 offset:16896
    ds_read_b64_tr_b16 a[34:35], v121 offset:25344
    v_mfma_f32_16x16x32_bf16 v[220:223], a[8:11], a[72:75], 0
    ds_read_b128 a[80:83], v124 offset:43008
    ds_read_b128 a[84:87], v126 offset:45056
    v_mfma_f32_16x16x32_bf16 v[160:163], a[12:15], a[64:67], 0
    ds_read_b64_tr_b16 a[36:37], v121 offset:16928
    ds_read_b64_tr_b16 a[38:39], v121 offset:25376
    v_mfma_f32_16x16x32_bf16 v[192:195], a[12:15], a[68:71], 0
    buffer_load_dwordx4 v114, s[32:35], s51 offen offset:2112 lds
    ds_read_b64_tr_b16 a[40:41], v121 offset:16960
    ds_read_b64_tr_b16 a[42:43], v121 offset:25408
    v_mfma_f32_16x16x32_bf16 v[224:227], a[12:15], a[72:75], 0
    ds_read_b64_tr_b16 a[44:45], v121 offset:16992
    ds_read_b64_tr_b16 a[46:47], v121 offset:25440
    v_mfma_f32_16x16x32_bf16 v[164:167], a[16:19], a[64:67], 0
    ds_read_b64_tr_b16 a[48:49], v122 offset:16896
    ds_read_b64_tr_b16 a[50:51], v122 offset:25344
    v_mfma_f32_16x16x32_bf16 v[196:199], a[16:19], a[68:71], 0
    buffer_load_dwordx4 v115, s[32:35], s51 offen offset:3168 lds
    ds_read_b64_tr_b16 a[52:53], v122 offset:16928
    ds_read_b64_tr_b16 a[54:55], v122 offset:25376
    v_mfma_f32_16x16x32_bf16 v[168:171], a[20:23], a[64:67], 0
    ds_read_b64_tr_b16 a[56:57], v122 offset:16960
    ds_read_b64_tr_b16 a[58:59], v122 offset:25408
    v_mfma_f32_16x16x32_bf16 v[200:203], a[20:23], a[68:71], 0
    ds_read_b64_tr_b16 a[60:61], v122 offset:16992
    ds_read_b64_tr_b16 a[62:63], v122 offset:25440
    v_mfma_f32_16x16x32_bf16 v[172:175], a[24:27], a[64:67], 0
    s_lshl_b32 s9, s3, 8
    v_mov_b32 v250, 50688
    v_bfe_u32 v249, v0, 6, 1
    v_mfma_f32_16x16x32_bf16 v[204:207], a[24:27], a[68:71], 0
    s_add_u32 s8, s8, s9
    s_add_u32 s8, s8, s80
    s_add_u32 s8, s8, 114688
    v_mfma_f32_16x16x32_bf16 v[176:179], a[28:31], a[64:67], 0
    s_bfe_u32 s9, s45, 0x30001
    s_lshl_b32 s9, s9, 10
    s_add_u32 s8, s8, s9
    v_mfma_f32_16x16x32_bf16 v[208:211], a[28:31], a[68:71], 0
    s_waitcnt vmcnt(4) lgkmcnt(0)
    s_barrier
    s_add_u32 m0, s89, 16896
    v_mfma_f32_16x16x32_bf16 v[148:151], a[32:35], a[76:79], v[148:151]
    buffer_load_dwordx4 v112, s[32:35], s52 offen lds
    v_mfma_f32_16x16x32_bf16 v[180:183], a[32:35], a[80:83], v[180:183]
    ds_read_b128 a[64:67], v123 offset:0
    ds_read_b64_tr_b16 a[0:1], v121 offset:33792
    v_mfma_f32_16x16x32_bf16 v[212:215], a[32:35], a[84:87], v[212:215]
    ds_read_b64_tr_b16 a[2:3], v121 offset:42240
    ds_read_b128 a[68:71], v123 offset:2048
    v_mfma_f32_16x16x32_bf16 v[152:155], a[36:39], a[76:79], v[152:155]
    ds_read_b64_tr_b16 a[4:5], v121 offset:33824
    ds_read_b64_tr_b16 a[6:7], v121 offset:42272
    v_mfma_f32_16x16x32_bf16 v[184:187], a[36:39], a[80:83], v[184:187]
    buffer_load_dwordx4 v113, s[32:35], s52 offen offset:1056 lds
    v_mfma_f32_16x16x32_bf16 v[216:219], a[36:39], a[84:87], v[216:219]
    ds_read_b128 a[72:75], v125 offset:4096
    ds_read_b64_tr_b16 a[8:9], v121 offset:33856
    v_mfma_f32_16x16x32_bf16 v[156:159], a[40:43], a[76:79], v[156:159]
    ds_read_b64_tr_b16 a[10:11], v121 offset:42304
    ds_read_b64_tr_b16 a[12:13], v121 offset:33888
    v_mfma_f32_16x16x32_bf16 v[188:191], a[40:43], a[80:83], v[188:191]
    ds_read_b64_tr_b16 a[14:15], v121 offset:42336
    ds_read_b64_tr_b16 a[16:17], v122 offset:33792
    v_mfma_f32_16x16x32_bf16 v[220:223], a[40:43], a[84:87], v[220:223]
    buffer_load_dwordx4 v114, s[32:35], s52 offen offset:2112 lds
    v_mfma_f32_16x16x32_bf16 v[160:163], a[44:47], a[76:79], v[160:163]
    ds_read_b64_tr_b16 a[18:19], v122 offset:42240
    ds_read_b64_tr_b16 a[20:21], v122 offset:33824
    v_mfma_f32_16x16x32_bf16 v[192:195], a[44:47], a[80:83], v[192:195]
    ds_read_b64_tr_b16 a[22:23], v122 offset:42272
    ds_read_b64_tr_b16 a[24:25], v122 offset:33856
    v_mfma_f32_16x16x32_bf16 v[224:227], a[44:47], a[84:87], v[224:227]
    ds_read_b64_tr_b16 a[26:27], v122 offset:42304
    ds_read_b64_tr_b16 a[28:29], v122 offset:33888
    v_mfma_f32_16x16x32_bf16 v[164:167], a[48:51], a[76:79], v[164:167]
    buffer_load_dwordx4 v115, s[32:35], s52 offen offset:3168 lds
    v_mfma_f32_16x16x32_bf16 v[196:199], a[48:51], a[80:83], v[196:199]
    ds_read_b64_tr_b16 a[30:31], v122 offset:42336
    ds_read_b128 a[84:87], v126 offset:4096
    v_mfma_f32_16x16x32_bf16 v[168:171], a[52:55], a[76:79], v[168:171]
    v_mfma_f32_16x16x32_bf16 v[200:203], a[52:55], a[80:83], v[200:203]
    v_mfma_f32_16x16x32_bf16 v[172:175], a[56:59], a[76:79], v[172:175]
    v_mfma_f32_16x16x32_bf16 v[204:207], a[56:59], a[80:83], v[204:207]
    v_mfma_f32_16x16x32_bf16 v[176:179], a[60:63], a[76:79], v[176:179]
    ds_read_b128 a[76:79], v124 offset:0
    v_mfma_f32_16x16x32_bf16 v[208:211], a[60:63], a[80:83], v[208:211]
    s_waitcnt vmcnt(4) lgkmcnt(1)
    s_barrier
    s_add_u32 m0, s89, 33792
    v_mfma_f32_16x16x32_bf16 v[148:151], a[0:3], a[64:67], v[148:151]
    buffer_load_dwordx4 v112, s[32:35], s53 offen lds
    v_mfma_f32_16x16x32_bf16 v[180:183], a[0:3], a[68:71], v[180:183]
    ds_read_b64_tr_b16 a[32:33], v121 offset:0
    ds_read_b64_tr_b16 a[34:35], v121 offset:8448
    v_mfma_f32_16x16x32_bf16 v[212:215], a[0:3], a[72:75], v[212:215]
    ds_read_b128 a[80:83], v124 offset:2048
    ds_read_b64_tr_b16 a[36:37], v121 offset:32
    v_mfma_f32_16x16x32_bf16 v[152:155], a[4:7], a[64:67], v[152:155]
    ds_read_b64_tr_b16 a[38:39], v121 offset:8480
    ds_read_b64_tr_b16 a[40:41], v121 offset:64
    v_mfma_f32_16x16x32_bf16 v[184:187], a[4:7], a[68:71], v[184:187]
    buffer_load_dwordx4 v113, s[32:35], s53 offen offset:1056 lds
    v_mfma_f32_16x16x32_bf16 v[216:219], a[4:7], a[72:75], v[216:219]
    ds_read_b64_tr_b16 a[42:43], v121 offset:8512
    ds_read_b64_tr_b16 a[44:45], v121 offset:96
    v_mfma_f32_16x16x32_bf16 v[156:159], a[8:11], a[64:67], v[156:159]
    ds_read_b64_tr_b16 a[46:47], v121 offset:8544
    ds_read_b64_tr_b16 a[48:49], v122 offset:0
    v_mfma_f32_16x16x32_bf16 v[188:191], a[8:11], a[68:71], v[188:191]
    ds_read_b64_tr_b16 a[50:51], v122 offset:8448
    ds_read_b64_tr_b16 a[52:53], v122 offset:32
    v_mfma_f32_16x16x32_bf16 v[220:223], a[8:11], a[72:75], v[220:223]
    buffer_load_dwordx4 v114, s[32:35], s53 offen offset:2112 lds
    v_mfma_f32_16x16x32_bf16 v[160:163], a[12:15], a[64:67], v[160:163]
    ds_read_b64_tr_b16 a[54:55], v122 offset:8480
    ds_read_b64_tr_b16 a[56:57], v122 offset:64
    v_mfma_f32_16x16x32_bf16 v[192:195], a[12:15], a[68:71], v[192:195]
    ds_read_b64_tr_b16 a[58:59], v122 offset:8512
    ds_read_b64_tr_b16 a[60:61], v122 offset:96
    v_mfma_f32_16x16x32_bf16 v[224:227], a[12:15], a[72:75], v[224:227]
    ds_read_b64_tr_b16 a[62:63], v122 offset:8544
    ds_read_b128 a[72:75], v125 offset:14336
    v_mfma_f32_16x16x32_bf16 v[164:167], a[16:19], a[64:67], v[164:167]
    buffer_load_dwordx4 v115, s[32:35], s53 offen offset:3168 lds
    v_mfma_f32_16x16x32_bf16 v[196:199], a[16:19], a[68:71], v[196:199]
    v_mfma_f32_16x16x32_bf16 v[168:171], a[20:23], a[64:67], v[168:171]
    v_mfma_f32_16x16x32_bf16 v[200:203], a[20:23], a[68:71], v[200:203]
    v_mfma_f32_16x16x32_bf16 v[172:175], a[24:27], a[64:67], v[172:175]
    v_mfma_f32_16x16x32_bf16 v[204:207], a[24:27], a[68:71], v[204:207]
    v_mfma_f32_16x16x32_bf16 v[176:179], a[28:31], a[64:67], v[176:179]
    ds_read_b128 a[64:67], v123 offset:10240
    v_mfma_f32_16x16x32_bf16 v[208:211], a[28:31], a[68:71], v[208:211]
    s_waitcnt vmcnt(4) lgkmcnt(1)
    s_barrier
    s_add_u32 m0, s90, 76288
    v_mfma_f32_16x16x32_bf16 v[148:151], a[32:35], a[76:79], v[148:151]
    buffer_load_dwordx4 v116, s[20:23], s67 offen lds
    v_mfma_f32_16x16x32_bf16 v[180:183], a[32:35], a[80:83], v[180:183]
    buffer_load_dwordx4 v117, s[20:23], s67 offen offset:1024 lds
    v_mfma_f32_16x16x32_bf16 v[212:215], a[32:35], a[84:87], v[212:215]
    buffer_load_dwordx4 v118, s[20:23], s67 offen offset:2048 lds
    v_mfma_f32_16x16x32_bf16 v[152:155], a[36:39], a[76:79], v[152:155]
    buffer_load_dwordx4 v119, s[20:23], s67 offen offset:3072 lds
    v_mfma_f32_16x16x32_bf16 v[184:187], a[36:39], a[80:83], v[184:187]
    ds_read_b64_tr_b16 a[0:1], v121 offset:16896
    s_add_u32 m0, s90, 80384
    v_mfma_f32_16x16x32_bf16 v[216:219], a[36:39], a[84:87], v[216:219]
    buffer_load_dwordx4 v120, s[20:23], s67 offen lds
    s_add_u32 m0, s89, 0
    v_mfma_f32_16x16x32_bf16 v[156:159], a[40:43], a[76:79], v[156:159]
    buffer_load_dwordx4 v112, s[32:35], s54 offen lds
    v_mfma_f32_16x16x32_bf16 v[188:191], a[40:43], a[80:83], v[188:191]
    ds_read_b64_tr_b16 a[2:3], v121 offset:25344
    ds_read_b128 a[68:71], v123 offset:12288
    v_mfma_f32_16x16x32_bf16 v[220:223], a[40:43], a[84:87], v[220:223]
    ds_read_b64_tr_b16 a[4:5], v121 offset:16928
    ds_read_b64_tr_b16 a[6:7], v121 offset:25376
    v_mfma_f32_16x16x32_bf16 v[160:163], a[44:47], a[76:79], v[160:163]
    buffer_load_dwordx4 v113, s[32:35], s54 offen offset:1056 lds
    v_mfma_f32_16x16x32_bf16 v[192:195], a[44:47], a[80:83], v[192:195]
    ds_read_b64_tr_b16 a[8:9], v121 offset:16960
    ds_read_b64_tr_b16 a[10:11], v121 offset:25408
    v_mfma_f32_16x16x32_bf16 v[224:227], a[44:47], a[84:87], v[224:227]
    ds_read_b64_tr_b16 a[12:13], v121 offset:16992
    ds_read_b64_tr_b16 a[14:15], v121 offset:25440
    v_mfma_f32_16x16x32_bf16 v[164:167], a[48:51], a[76:79], v[164:167]
    ds_read_b64_tr_b16 a[16:17], v122 offset:16896
    ds_read_b64_tr_b16 a[18:19], v122 offset:25344
    v_mfma_f32_16x16x32_bf16 v[196:199], a[48:51], a[80:83], v[196:199]
    buffer_load_dwordx4 v114, s[32:35], s54 offen offset:2112 lds
    ds_read_b64_tr_b16 a[20:21], v122 offset:16928
    ds_read_b64_tr_b16 a[22:23], v122 offset:25376
    v_mfma_f32_16x16x32_bf16 v[168:171], a[52:55], a[76:79], v[168:171]
    ds_read_b64_tr_b16 a[24:25], v122 offset:16960
    ds_read_b64_tr_b16 a[26:27], v122 offset:25408
    v_mfma_f32_16x16x32_bf16 v[200:203], a[52:55], a[80:83], v[200:203]
    ds_read_b64_tr_b16 a[28:29], v122 offset:16992
    ds_read_b64_tr_b16 a[30:31], v122 offset:25440
    v_mfma_f32_16x16x32_bf16 v[172:175], a[56:59], a[76:79], v[172:175]
    buffer_load_dwordx4 v115, s[32:35], s54 offen offset:3168 lds
    v_mfma_f32_16x16x32_bf16 v[204:207], a[56:59], a[80:83], v[204:207]
    ds_read_b128 a[84:87], v126 offset:14336
    s_add_u32 m0, s88, 96768
    v_mfma_f32_16x16x32_bf16 v[176:179], a[60:63], a[76:79], v[176:179]
    buffer_load_dwordx4 v9, s[24:27], s80 offen nt lds
    v_mfma_f32_16x16x32_bf16 v[208:211], a[60:63], a[80:83], v[208:211]
    s_waitcnt vmcnt(10) lgkmcnt(1)
    s_barrier
    s_add_u32 m0, s88, 98592
    v_mfma_f32_16x16x32_bf16 v[148:151], a[0:3], a[64:67], v[148:151]
    buffer_load_dwordx4 v9, s[24:27], s80 offen offset:256 nt lds
    s_add_u32 m0, s88, 100416
    v_mfma_f32_16x16x32_bf16 v[180:183], a[0:3], a[68:71], v[180:183]
    buffer_load_dwordx4 v9, s[24:27], s80 offen offset:512 nt lds
    s_add_u32 m0, s88, 102240
    v_mfma_f32_16x16x32_bf16 v[212:215], a[0:3], a[72:75], v[212:215]
    buffer_load_dwordx4 v9, s[24:27], s80 offen offset:768 nt lds
    s_add_u32 m0, s89, 16896
    v_mfma_f32_16x16x32_bf16 v[152:155], a[4:7], a[64:67], v[152:155]
    buffer_load_dwordx4 v112, s[32:35], s55 offen lds
    v_mfma_f32_16x16x32_bf16 v[184:187], a[4:7], a[68:71], v[184:187]
    buffer_load_dwordx4 v113, s[32:35], s55 offen offset:1056 lds
    v_mfma_f32_16x16x32_bf16 v[216:219], a[4:7], a[72:75], v[216:219]
    ds_read_b128 a[76:79], v124 offset:10240
    ds_read_b64_tr_b16 a[32:33], v121 offset:33792
    v_mfma_f32_16x16x32_bf16 v[156:159], a[8:11], a[64:67], v[156:159]
    ds_read_b64_tr_b16 a[34:35], v121 offset:42240
    ds_read_b128 a[80:83], v124 offset:12288
    v_mfma_f32_16x16x32_bf16 v[188:191], a[8:11], a[68:71], v[188:191]
    ds_read_b64_tr_b16 a[36:37], v121 offset:33824
    ds_read_b64_tr_b16 a[38:39], v121 offset:42272
    v_mfma_f32_16x16x32_bf16 v[220:223], a[8:11], a[72:75], v[220:223]
    buffer_load_dwordx4 v114, s[32:35], s55 offen offset:2112 lds
    v_mfma_f32_16x16x32_bf16 v[160:163], a[12:15], a[64:67], v[160:163]
    ds_read_b64_tr_b16 a[40:41], v121 offset:33856
    ds_read_b64_tr_b16 a[42:43], v121 offset:42304
    v_mfma_f32_16x16x32_bf16 v[192:195], a[12:15], a[68:71], v[192:195]
    ds_read_b64_tr_b16 a[44:45], v121 offset:33888
    ds_read_b64_tr_b16 a[46:47], v121 offset:42336
    v_mfma_f32_16x16x32_bf16 v[224:227], a[12:15], a[72:75], v[224:227]
    ds_read_b64_tr_b16 a[48:49], v122 offset:33792
    ds_read_b64_tr_b16 a[50:51], v122 offset:42240
    v_mfma_f32_16x16x32_bf16 v[164:167], a[16:19], a[64:67], v[164:167]
    buffer_load_dwordx4 v115, s[32:35], s55 offen offset:3168 lds
    v_mfma_f32_16x16x32_bf16 v[196:199], a[16:19], a[68:71], v[196:199]
    ds_read_b64_tr_b16 a[52:53], v122 offset:33824
    ds_read_b64_tr_b16 a[54:55], v122 offset:42272
    v_mfma_f32_16x16x32_bf16 v[168:171], a[20:23], a[64:67], v[168:171]
    ds_read_b64_tr_b16 a[56:57], v122 offset:33856
    ds_read_b64_tr_b16 a[58:59], v122 offset:42304
    v_mfma_f32_16x16x32_bf16 v[200:203], a[20:23], a[68:71], v[200:203]
    ds_read_b64_tr_b16 a[60:61], v122 offset:33888
    ds_read_b64_tr_b16 a[62:63], v122 offset:42336
    v_mfma_f32_16x16x32_bf16 v[172:175], a[24:27], a[64:67], v[172:175]
    v_mfma_f32_16x16x32_bf16 v[204:207], a[24:27], a[68:71], v[204:207]
    v_mfma_f32_16x16x32_bf16 v[176:179], a[28:31], a[64:67], v[176:179]
    v_mfma_f32_16x16x32_bf16 v[208:211], a[28:31], a[68:71], v[208:211]
    s_waitcnt vmcnt(8) lgkmcnt(0)
    s_barrier
    s_add_u32 m0, s89, 33792
    v_mfma_f32_16x16x32_bf16 v[148:151], a[32:35], a[76:79], v[148:151]
    buffer_load_dwordx4 v112, s[32:35], s56 offen lds
    v_mfma_f32_16x16x32_bf16 v[180:183], a[32:35], a[80:83], v[180:183]
    ds_read_b128 a[64:67], v123 offset:20480
    ds_read_b64_tr_b16 a[0:1], v121 offset:0
    v_mfma_f32_16x16x32_bf16 v[212:215], a[32:35], a[84:87], v[212:215]
    ds_read_b64_tr_b16 a[2:3], v121 offset:8448
    ds_read_b128 a[68:71], v123 offset:22528
    v_mfma_f32_16x16x32_bf16 v[152:155], a[36:39], a[76:79], v[152:155]
    buffer_load_dwordx4 v113, s[32:35], s56 offen offset:1056 lds
    v_mfma_f32_16x16x32_bf16 v[184:187], a[36:39], a[80:83], v[184:187]
    ds_read_b64_tr_b16 a[4:5], v121 offset:32
    ds_read_b64_tr_b16 a[6:7], v121 offset:8480
    v_mfma_f32_16x16x32_bf16 v[216:219], a[36:39], a[84:87], v[216:219]
    ds_read_b128 a[72:75], v125 offset:24576
    ds_read_b64_tr_b16 a[8:9], v121 offset:64
    v_mfma_f32_16x16x32_bf16 v[156:159], a[40:43], a[76:79], v[156:159]
    buffer_load_dwordx4 v114, s[32:35], s56 offen offset:2112 lds
    v_mfma_f32_16x16x32_bf16 v[188:191], a[40:43], a[80:83], v[188:191]
    ds_read_b64_tr_b16 a[10:11], v121 offset:8512
    ds_read_b64_tr_b16 a[12:13], v121 offset:96
    v_mfma_f32_16x16x32_bf16 v[220:223], a[40:43], a[84:87], v[220:223]
    ds_read_b64_tr_b16 a[14:15], v121 offset:8544
    ds_read_b64_tr_b16 a[16:17], v122 offset:0
    v_mfma_f32_16x16x32_bf16 v[160:163], a[44:47], a[76:79], v[160:163]
    buffer_load_dwordx4 v115, s[32:35], s56 offen offset:3168 lds
    v_mfma_f32_16x16x32_bf16 v[192:195], a[44:47], a[80:83], v[192:195]
    ds_read_b64_tr_b16 a[18:19], v122 offset:8448
    ds_read_b64_tr_b16 a[20:21], v122 offset:32
    v_mfma_f32_16x16x32_bf16 v[224:227], a[44:47], a[84:87], v[224:227]
    ds_read_b64_tr_b16 a[22:23], v122 offset:8480
    ds_read_b64_tr_b16 a[24:25], v122 offset:64
    v_mfma_f32_16x16x32_bf16 v[164:167], a[48:51], a[76:79], v[164:167]
    ds_read_b64_tr_b16 a[26:27], v122 offset:8512
    s_add_u32 m0, s90, 55808
    v_mfma_f32_16x16x32_bf16 v[196:199], a[48:51], a[80:83], v[196:199]
    buffer_load_dwordx4 v116, s[20:23], s68 offen lds
    v_mfma_f32_16x16x32_bf16 v[168:171], a[52:55], a[76:79], v[168:171]
    ds_read_b64_tr_b16 a[28:29], v122 offset:96
    ds_read_b64_tr_b16 a[30:31], v122 offset:8544
    v_mfma_f32_16x16x32_bf16 v[200:203], a[52:55], a[80:83], v[200:203]
    buffer_load_dwordx4 v117, s[20:23], s68 offen offset:1024 lds
    v_mfma_f32_16x16x32_bf16 v[172:175], a[56:59], a[76:79], v[172:175]
    ds_read_b128 a[84:87], v126 offset:24576
    v_mfma_f32_16x16x32_bf16 v[204:207], a[56:59], a[80:83], v[204:207]
    v_mfma_f32_16x16x32_bf16 v[176:179], a[60:63], a[76:79], v[176:179]
    ds_read_b128 a[76:79], v124 offset:20480
    v_mfma_f32_16x16x32_bf16 v[208:211], a[60:63], a[80:83], v[208:211]
    s_waitcnt vmcnt(6) lgkmcnt(2)
    s_barrier
    s_add_u32 m0, s89, 0
    v_mfma_f32_16x16x32_bf16 v[148:151], a[0:3], a[64:67], v[148:151]
    buffer_load_dwordx4 v112, s[32:35], s57 offen lds
    v_mfma_f32_16x16x32_bf16 v[180:183], a[0:3], a[68:71], v[180:183]
    ds_read_b64_tr_b16 a[32:33], v121 offset:16896
    ds_read_b64_tr_b16 a[34:35], v121 offset:25344
    v_mfma_f32_16x16x32_bf16 v[212:215], a[0:3], a[72:75], v[212:215]
    ds_read_b128 a[80:83], v124 offset:22528
    ds_read_b64_tr_b16 a[36:37], v121 offset:16928
    v_mfma_f32_16x16x32_bf16 v[152:155], a[4:7], a[64:67], v[152:155]
    buffer_load_dwordx4 v113, s[32:35], s57 offen offset:1056 lds
    v_mfma_f32_16x16x32_bf16 v[184:187], a[4:7], a[68:71], v[184:187]
    ds_read_b64_tr_b16 a[38:39], v121 offset:25376
    ds_read_b64_tr_b16 a[40:41], v121 offset:16960
    v_mfma_f32_16x16x32_bf16 v[216:219], a[4:7], a[72:75], v[216:219]
    ds_read_b64_tr_b16 a[42:43], v121 offset:25408
    ds_read_b64_tr_b16 a[44:45], v121 offset:16992
    v_mfma_f32_16x16x32_bf16 v[156:159], a[8:11], a[64:67], v[156:159]
    buffer_load_dwordx4 v114, s[32:35], s57 offen offset:2112 lds
    v_mfma_f32_16x16x32_bf16 v[188:191], a[8:11], a[68:71], v[188:191]
    ds_read_b64_tr_b16 a[46:47], v121 offset:25440
    ds_read_b64_tr_b16 a[48:49], v122 offset:16896
    v_mfma_f32_16x16x32_bf16 v[220:223], a[8:11], a[72:75], v[220:223]
    ds_read_b64_tr_b16 a[50:51], v122 offset:25344
    ds_read_b64_tr_b16 a[52:53], v122 offset:16928
    v_mfma_f32_16x16x32_bf16 v[160:163], a[12:15], a[64:67], v[160:163]
    buffer_load_dwordx4 v115, s[32:35], s57 offen offset:3168 lds
    v_mfma_f32_16x16x32_bf16 v[192:195], a[12:15], a[68:71], v[192:195]
    ds_read_b64_tr_b16 a[54:55], v122 offset:25376
    ds_read_b64_tr_b16 a[56:57], v122 offset:16960
    v_mfma_f32_16x16x32_bf16 v[224:227], a[12:15], a[72:75], v[224:227]
    ds_read_b64_tr_b16 a[58:59], v122 offset:25408
    ds_read_b64_tr_b16 a[60:61], v122 offset:16992
    v_mfma_f32_16x16x32_bf16 v[164:167], a[16:19], a[64:67], v[164:167]
    ds_read_b64_tr_b16 a[62:63], v122 offset:25440
    s_add_u32 m0, s90, 55808
    v_mfma_f32_16x16x32_bf16 v[196:199], a[16:19], a[68:71], v[196:199]
    buffer_load_dwordx4 v118, s[20:23], s68 offen offset:2048 lds
    v_mfma_f32_16x16x32_bf16 v[168:171], a[20:23], a[64:67], v[168:171]
    ds_read_b128 a[72:75], v125 offset:34816
    v_mfma_f32_16x16x32_bf16 v[200:203], a[20:23], a[68:71], v[200:203]
    buffer_load_dwordx4 v119, s[20:23], s68 offen offset:3072 lds
    v_mfma_f32_16x16x32_bf16 v[172:175], a[24:27], a[64:67], v[172:175]
    v_mfma_f32_16x16x32_bf16 v[204:207], a[24:27], a[68:71], v[204:207]
    v_mfma_f32_16x16x32_bf16 v[176:179], a[28:31], a[64:67], v[176:179]
    ds_read_b128 a[64:67], v123 offset:30720
    v_mfma_f32_16x16x32_bf16 v[208:211], a[28:31], a[68:71], v[208:211]
    s_waitcnt vmcnt(8) lgkmcnt(1)
    s_barrier
    s_add_u32 m0, s89, 16896
    v_mfma_f32_16x16x32_bf16 v[148:151], a[32:35], a[76:79], v[148:151]
    buffer_load_dwordx4 v112, s[32:35], s58 offen lds
    v_mfma_f32_16x16x32_bf16 v[180:183], a[32:35], a[80:83], v[180:183]
    ds_read_b64_tr_b16 a[0:1], v121 offset:33792
    ds_read_b64_tr_b16 a[2:3], v121 offset:42240
    v_mfma_f32_16x16x32_bf16 v[212:215], a[32:35], a[84:87], v[212:215]
    ds_read_b128 a[68:71], v123 offset:32768
    ds_read_b64_tr_b16 a[4:5], v121 offset:33824
    v_mfma_f32_16x16x32_bf16 v[152:155], a[36:39], a[76:79], v[152:155]
    buffer_load_dwordx4 v113, s[32:35], s58 offen offset:1056 lds
    v_mfma_f32_16x16x32_bf16 v[184:187], a[36:39], a[80:83], v[184:187]
    ds_read_b64_tr_b16 a[6:7], v121 offset:42272
    ds_read_b64_tr_b16 a[8:9], v121 offset:33856
    v_mfma_f32_16x16x32_bf16 v[216:219], a[36:39], a[84:87], v[216:219]
    ds_read_b64_tr_b16 a[10:11], v121 offset:42304
    ds_read_b64_tr_b16 a[12:13], v121 offset:33888
    v_mfma_f32_16x16x32_bf16 v[156:159], a[40:43], a[76:79], v[156:159]
    buffer_load_dwordx4 v114, s[32:35], s58 offen offset:2112 lds
    v_mfma_f32_16x16x32_bf16 v[188:191], a[40:43], a[80:83], v[188:191]
    ds_read_b64_tr_b16 a[14:15], v121 offset:42336
    ds_read_b64_tr_b16 a[16:17], v122 offset:33792
    v_mfma_f32_16x16x32_bf16 v[220:223], a[40:43], a[84:87], v[220:223]
    ds_read_b64_tr_b16 a[18:19], v122 offset:42240
    ds_read_b64_tr_b16 a[20:21], v122 offset:33824
    v_mfma_f32_16x16x32_bf16 v[160:163], a[44:47], a[76:79], v[160:163]
    buffer_load_dwordx4 v115, s[32:35], s58 offen offset:3168 lds
    v_mfma_f32_16x16x32_bf16 v[192:195], a[44:47], a[80:83], v[192:195]
    ds_read_b64_tr_b16 a[22:23], v122 offset:42272
    ds_read_b64_tr_b16 a[24:25], v122 offset:33856
    v_mfma_f32_16x16x32_bf16 v[224:227], a[44:47], a[84:87], v[224:227]
    ds_read_b64_tr_b16 a[26:27], v122 offset:42304
    ds_read_b64_tr_b16 a[28:29], v122 offset:33888
    v_mfma_f32_16x16x32_bf16 v[164:167], a[48:51], a[76:79], v[164:167]
    ds_read_b64_tr_b16 a[30:31], v122 offset:42336
    s_add_u32 m0, s90, 59904
    v_mfma_f32_16x16x32_bf16 v[196:199], a[48:51], a[80:83], v[196:199]
    buffer_load_dwordx4 v120, s[20:23], s68 offen lds
    v_mfma_f32_16x16x32_bf16 v[168:171], a[52:55], a[76:79], v[168:171]
    ds_read_b128 a[84:87], v126 offset:34816
    v_mfma_f32_16x16x32_bf16 v[200:203], a[52:55], a[80:83], v[200:203]
    v_mfma_f32_16x16x32_bf16 v[172:175], a[56:59], a[76:79], v[172:175]
    v_mfma_f32_16x16x32_bf16 v[204:207], a[56:59], a[80:83], v[204:207]
    v_mfma_f32_16x16x32_bf16 v[176:179], a[60:63], a[76:79], v[176:179]
    ds_read_b128 a[76:79], v124 offset:30720
    v_mfma_f32_16x16x32_bf16 v[208:211], a[60:63], a[80:83], v[208:211]
    s_waitcnt vmcnt(7) lgkmcnt(1)
    s_barrier
    s_add_u32 m0, s89, 33792
    s_load_dword s6, s[40:41], s8 glc
    v_mfma_f32_16x16x32_bf16 v[148:151], a[0:3], a[64:67], v[148:151]
    buffer_load_dwordx4 v112, s[32:35], s59 offen lds
    v_mfma_f32_16x16x32_bf16 v[180:183], a[0:3], a[68:71], v[180:183]
    ds_read_b64_tr_b16 a[32:33], v121 offset:0
    ds_read_b64_tr_b16 a[34:35], v121 offset:8448
    v_mfma_f32_16x16x32_bf16 v[212:215], a[0:3], a[72:75], v[212:215]
    ds_read_b128 a[80:83], v124 offset:32768
    ds_read_b64_tr_b16 a[36:37], v121 offset:32
    v_mfma_f32_16x16x32_bf16 v[152:155], a[4:7], a[64:67], v[152:155]
    buffer_load_dwordx4 v113, s[32:35], s59 offen offset:1056 lds
    v_mfma_f32_16x16x32_bf16 v[184:187], a[4:7], a[68:71], v[184:187]
    ds_read_b64_tr_b16 a[38:39], v121 offset:8480
    ds_read_b64_tr_b16 a[40:41], v121 offset:64
    v_mfma_f32_16x16x32_bf16 v[216:219], a[4:7], a[72:75], v[216:219]
    ds_read_b64_tr_b16 a[42:43], v121 offset:8512
    ds_read_b64_tr_b16 a[44:45], v121 offset:96
    v_mfma_f32_16x16x32_bf16 v[156:159], a[8:11], a[64:67], v[156:159]
    ds_read_b64_tr_b16 a[46:47], v121 offset:8544
    ds_read_b64_tr_b16 a[48:49], v122 offset:0
    v_mfma_f32_16x16x32_bf16 v[188:191], a[8:11], a[68:71], v[188:191]
    buffer_load_dwordx4 v114, s[32:35], s59 offen offset:2112 lds
    v_mfma_f32_16x16x32_bf16 v[220:223], a[8:11], a[72:75], v[220:223]
    ds_read_b64_tr_b16 a[50:51], v122 offset:8448
    ds_read_b64_tr_b16 a[52:53], v122 offset:32
    v_mfma_f32_16x16x32_bf16 v[160:163], a[12:15], a[64:67], v[160:163]
    ds_read_b64_tr_b16 a[54:55], v122 offset:8480
    ds_read_b64_tr_b16 a[56:57], v122 offset:64
    v_mfma_f32_16x16x32_bf16 v[192:195], a[12:15], a[68:71], v[192:195]
    ds_read_b64_tr_b16 a[58:59], v122 offset:8512
    ds_read_b64_tr_b16 a[60:61], v122 offset:96
    v_mfma_f32_16x16x32_bf16 v[224:227], a[12:15], a[72:75], v[224:227]
    buffer_load_dwordx4 v115, s[32:35], s59 offen offset:3168 lds
    v_mfma_f32_16x16x32_bf16 v[164:167], a[16:19], a[64:67], v[164:167]
    ds_read_b64_tr_b16 a[62:63], v122 offset:8544
    v_mfma_f32_16x16x32_bf16 v[196:199], a[16:19], a[68:71], v[196:199]
    v_mfma_f32_16x16x32_bf16 v[168:171], a[20:23], a[64:67], v[168:171]
    v_mfma_f32_16x16x32_bf16 v[200:203], a[20:23], a[68:71], v[200:203]
    v_mfma_f32_16x16x32_bf16 v[172:175], a[24:27], a[64:67], v[172:175]
    v_mfma_f32_16x16x32_bf16 v[204:207], a[24:27], a[68:71], v[204:207]
    v_mfma_f32_16x16x32_bf16 v[176:179], a[28:31], a[64:67], v[176:179]
    v_mfma_f32_16x16x32_bf16 v[208:211], a[28:31], a[68:71], v[208:211]
    s_waitcnt lgkmcnt(0)
    s_waitcnt lgkmcnt(0)
    ds_write_b32 v250, v249
    s_waitcnt vmcnt(4)
    s_barrier
    s_add_u32 m0, s89, 0
    v_mfma_f32_16x16x32_bf16 v[148:151], a[32:35], a[76:79], v[148:151]
    buffer_load_dwordx4 v112, s[32:35], s60 offen lds
    v_mfma_f32_16x16x32_bf16 v[180:183], a[32:35], a[80:83], v[180:183]
    ds_read_b128 a[64:67], v123 offset:0
    ds_read_b64_tr_b16 a[0:1], v121 offset:16896
    v_mfma_f32_16x16x32_bf16 v[212:215], a[32:35], a[84:87], v[212:215]
    ds_read_b64_tr_b16 a[2:3], v121 offset:25344
    ds_read_b128 a[68:71], v123 offset:2048
    v_mfma_f32_16x16x32_bf16 v[152:155], a[36:39], a[76:79], v[152:155]
    buffer_load_dwordx4 v113, s[32:35], s60 offen offset:1056 lds
    v_mfma_f32_16x16x32_bf16 v[184:187], a[36:39], a[80:83], v[184:187]
    ds_read_b64_tr_b16 a[4:5], v121 offset:16928
    ds_read_b64_tr_b16 a[6:7], v121 offset:25376
    v_mfma_f32_16x16x32_bf16 v[216:219], a[36:39], a[84:87], v[216:219]
    ds_read_b128 a[72:75], v125 offset:4096
    ds_read_b64_tr_b16 a[8:9], v121 offset:16960
    v_mfma_f32_16x16x32_bf16 v[156:159], a[40:43], a[76:79], v[156:159]
    buffer_load_dwordx4 v114, s[32:35], s60 offen offset:2112 lds
    v_mfma_f32_16x16x32_bf16 v[188:191], a[40:43], a[80:83], v[188:191]
    ds_read_b64_tr_b16 a[10:11], v121 offset:25408
    ds_read_b64_tr_b16 a[12:13], v121 offset:16992
    v_mfma_f32_16x16x32_bf16 v[220:223], a[40:43], a[84:87], v[220:223]
    ds_read_b64_tr_b16 a[14:15], v121 offset:25440
    ds_read_b64_tr_b16 a[16:17], v122 offset:16896
    v_mfma_f32_16x16x32_bf16 v[160:163], a[44:47], a[76:79], v[160:163]
    buffer_load_dwordx4 v115, s[32:35], s60 offen offset:3168 lds
    v_mfma_f32_16x16x32_bf16 v[192:195], a[44:47], a[80:83], v[192:195]
    ds_read_b64_tr_b16 a[18:19], v122 offset:25344
    ds_read_b64_tr_b16 a[20:21], v122 offset:16928
    v_mfma_f32_16x16x32_bf16 v[224:227], a[44:47], a[84:87], v[224:227]
    ds_read_b64_tr_b16 a[22:23], v122 offset:25376
    ds_read_b64_tr_b16 a[24:25], v122 offset:16960
    v_mfma_f32_16x16x32_bf16 v[164:167], a[48:51], a[76:79], v[164:167]
    ds_read_b64_tr_b16 a[26:27], v122 offset:25408
    s_add_u32 m0, s90, 76288
    v_mfma_f32_16x16x32_bf16 v[196:199], a[48:51], a[80:83], v[196:199]
    buffer_load_dwordx4 v116, s[20:23], s69 offen lds
    v_mfma_f32_16x16x32_bf16 v[168:171], a[52:55], a[76:79], v[168:171]
    ds_read_b64_tr_b16 a[28:29], v122 offset:16992
    ds_read_b64_tr_b16 a[30:31], v122 offset:25440
    v_mfma_f32_16x16x32_bf16 v[200:203], a[52:55], a[80:83], v[200:203]
    buffer_load_dwordx4 v117, s[20:23], s69 offen offset:1024 lds
    v_mfma_f32_16x16x32_bf16 v[172:175], a[56:59], a[76:79], v[172:175]
    ds_read_b128 a[84:87], v126 offset:4096
    v_mfma_f32_16x16x32_bf16 v[204:207], a[56:59], a[80:83], v[204:207]
    v_mfma_f32_16x16x32_bf16 v[176:179], a[60:63], a[76:79], v[176:179]
    ds_read_b128 a[76:79], v124 offset:0
    v_mfma_f32_16x16x32_bf16 v[208:211], a[60:63], a[80:83], v[208:211]
    s_waitcnt vmcnt(6) lgkmcnt(2)
    s_barrier
    s_add_u32 m0, s89, 16896
    v_mfma_f32_16x16x32_bf16 v[148:151], a[0:3], a[64:67], v[148:151]
    buffer_load_dwordx4 v112, s[32:35], s61 offen lds
    v_mfma_f32_16x16x32_bf16 v[180:183], a[0:3], a[68:71], v[180:183]
    ds_read_b64_tr_b16 a[32:33], v121 offset:33792
    ds_read_b64_tr_b16 a[34:35], v121 offset:42240
    v_mfma_f32_16x16x32_bf16 v[212:215], a[0:3], a[72:75], v[212:215]
    ds_read_b128 a[80:83], v124 offset:2048
    ds_read_b64_tr_b16 a[36:37], v121 offset:33824
    v_mfma_f32_16x16x32_bf16 v[152:155], a[4:7], a[64:67], v[152:155]
    buffer_load_dwordx4 v113, s[32:35], s61 offen offset:1056 lds
    v_mfma_f32_16x16x32_bf16 v[184:187], a[4:7], a[68:71], v[184:187]
    ds_read_b64_tr_b16 a[38:39], v121 offset:42272
    ds_read_b64_tr_b16 a[40:41], v121 offset:33856
    v_mfma_f32_16x16x32_bf16 v[216:219], a[4:7], a[72:75], v[216:219]
    ds_read_b64_tr_b16 a[42:43], v121 offset:42304
    ds_read_b64_tr_b16 a[44:45], v121 offset:33888
    v_mfma_f32_16x16x32_bf16 v[156:159], a[8:11], a[64:67], v[156:159]
    buffer_load_dwordx4 v114, s[32:35], s61 offen offset:2112 lds
    v_mfma_f32_16x16x32_bf16 v[188:191], a[8:11], a[68:71], v[188:191]
    ds_read_b64_tr_b16 a[46:47], v121 offset:42336
    ds_read_b64_tr_b16 a[48:49], v122 offset:33792
    v_mfma_f32_16x16x32_bf16 v[220:223], a[8:11], a[72:75], v[220:223]
    ds_read_b64_tr_b16 a[50:51], v122 offset:42240
    ds_read_b64_tr_b16 a[52:53], v122 offset:33824
    v_mfma_f32_16x16x32_bf16 v[160:163], a[12:15], a[64:67], v[160:163]
    buffer_load_dwordx4 v115, s[32:35], s61 offen offset:3168 lds
    v_mfma_f32_16x16x32_bf16 v[192:195], a[12:15], a[68:71], v[192:195]
    ds_read_b64_tr_b16 a[54:55], v122 offset:42272
    ds_read_b64_tr_b16 a[56:57], v122 offset:33856
    v_mfma_f32_16x16x32_bf16 v[224:227], a[12:15], a[72:75], v[224:227]
    ds_read_b64_tr_b16 a[58:59], v122 offset:42304
    ds_read_b64_tr_b16 a[60:61], v122 offset:33888
    v_mfma_f32_16x16x32_bf16 v[164:167], a[16:19], a[64:67], v[164:167]
    ds_read_b64_tr_b16 a[62:63], v122 offset:42336
    s_add_u32 m0, s90, 76288
    v_mfma_f32_16x16x32_bf16 v[196:199], a[16:19], a[68:71], v[196:199]
    buffer_load_dwordx4 v118, s[20:23], s69 offen offset:2048 lds
    v_mfma_f32_16x16x32_bf16 v[168:171], a[20:23], a[64:67], v[168:171]
    ds_read_b32 v249, v250
    ds_read_b128 a[72:75], v125 offset:14336
    v_mfma_f32_16x16x32_bf16 v[200:203], a[20:23], a[68:71], v[200:203]
    buffer_load_dwordx4 v119, s[20:23], s69 offen offset:3072 lds
    v_mfma_f32_16x16x32_bf16 v[172:175], a[24:27], a[64:67], v[172:175]
    s_getreg_b32 s8, hwreg(HW_REG_XCC_ID, 2, 1)
    v_mfma_f32_16x16x32_bf16 v[204:207], a[24:27], a[68:71], v[204:207]
    v_mfma_f32_16x16x32_bf16 v[176:179], a[28:31], a[64:67], v[176:179]
    ds_read_b128 a[64:67], v123 offset:10240
    v_mfma_f32_16x16x32_bf16 v[208:211], a[28:31], a[68:71], v[208:211]
    s_waitcnt vmcnt(8) lgkmcnt(1)
    s_barrier
    s_add_u32 m0, s89, 33792
    v_mfma_f32_16x16x32_bf16 v[148:151], a[32:35], a[76:79], v[148:151]
    buffer_load_dwordx4 v112, s[32:35], s62 offen lds
    v_mfma_f32_16x16x32_bf16 v[180:183], a[32:35], a[80:83], v[180:183]
    ds_read_b64_tr_b16 a[0:1], v121 offset:0
    v_xor_b32 v249, s8, v249
    v_mfma_f32_16x16x32_bf16 v[212:215], a[32:35], a[84:87], v[212:215]
    ds_read_b64_tr_b16 a[2:3], v121 offset:8448
    v_lshl_or_b32 v249, v249, 16, 1
    v_mfma_f32_16x16x32_bf16 v[152:155], a[36:39], a[76:79], v[152:155]
    ds_read_b128 a[68:71], v123 offset:12288
    v_lshlrev_b32 v254, s45, v249
    v_mfma_f32_16x16x32_bf16 v[184:187], a[36:39], a[80:83], v[184:187]
    buffer_load_dwordx4 v113, s[32:35], s62 offen offset:1056 lds
    v_mfma_f32_16x16x32_bf16 v[216:219], a[36:39], a[84:87], v[216:219]
    ds_read_b64_tr_b16 a[4:5], v121 offset:32
    ds_read_b64_tr_b16 a[6:7], v121 offset:8480
    v_mfma_f32_16x16x32_bf16 v[156:159], a[40:43], a[76:79], v[156:159]
    buffer_load_dwordx4 v114, s[32:35], s62 offen offset:2112 lds
    v_mfma_f32_16x16x32_bf16 v[188:191], a[40:43], a[80:83], v[188:191]
    ds_read_b64_tr_b16 a[8:9], v121 offset:64
    ds_read_b64_tr_b16 a[10:11], v121 offset:8512
    v_mfma_f32_16x16x32_bf16 v[220:223], a[40:43], a[84:87], v[220:223]
    ds_read_b64_tr_b16 a[12:13], v121 offset:96
    ds_read_b64_tr_b16 a[14:15], v121 offset:8544
    v_mfma_f32_16x16x32_bf16 v[160:163], a[44:47], a[76:79], v[160:163]
    buffer_load_dwordx4 v115, s[32:35], s62 offen offset:3168 lds
    v_mfma_f32_16x16x32_bf16 v[192:195], a[44:47], a[80:83], v[192:195]
    ds_read_b64_tr_b16 a[16:17], v122 offset:0
    ds_read_b64_tr_b16 a[18:19], v122 offset:8448
    v_mfma_f32_16x16x32_bf16 v[224:227], a[44:47], a[84:87], v[224:227]
    ds_read_b64_tr_b16 a[20:21], v122 offset:32
    ds_read_b64_tr_b16 a[22:23], v122 offset:8480
    v_mfma_f32_16x16x32_bf16 v[164:167], a[48:51], a[76:79], v[164:167]
    ds_read_b64_tr_b16 a[24:25], v122 offset:64
    s_add_u32 m0, s90, 80384
    v_mfma_f32_16x16x32_bf16 v[196:199], a[48:51], a[80:83], v[196:199]
    buffer_load_dwordx4 v120, s[20:23], s69 offen lds
    v_mfma_f32_16x16x32_bf16 v[168:171], a[52:55], a[76:79], v[168:171]
    ds_read_b64_tr_b16 a[26:27], v122 offset:8512
    ds_read_b64_tr_b16 a[28:29], v122 offset:96
    v_mfma_f32_16x16x32_bf16 v[200:203], a[52:55], a[80:83], v[200:203]
    ds_read_b64_tr_b16 a[30:31], v122 offset:8544
    ds_read_b128 a[84:87], v126 offset:14336
    v_mfma_f32_16x16x32_bf16 v[172:175], a[56:59], a[76:79], v[172:175]
    s_lshl_b32 s8, s8, s45
    v_mfma_f32_16x16x32_bf16 v[204:207], a[56:59], a[80:83], v[204:207]
    v_mov_b32 v255, s8
    v_mfma_f32_16x16x32_bf16 v[176:179], a[60:63], a[76:79], v[176:179]
    ds_read_b128 a[76:79], v124 offset:10240
    v_mfma_f32_16x16x32_bf16 v[208:211], a[60:63], a[80:83], v[208:211]
    s_waitcnt vmcnt(7) lgkmcnt(1)
    s_barrier
    s_add_u32 m0, s89, 0
    v_mfma_f32_16x16x32_bf16 v[148:151], a[0:3], a[64:67], v[148:151]
    buffer_load_dwordx4 v112, s[32:35], s63 offen lds
    v_mfma_f32_16x16x32_bf16 v[180:183], a[0:3], a[68:71], v[180:183]
    ds_read_b64_tr_b16 a[32:33], v121 offset:16896
    ds_read_b64_tr_b16 a[34:35], v121 offset:25344
    v_mfma_f32_16x16x32_bf16 v[212:215], a[0:3], a[72:75], v[212:215]
    ds_read_b128 a[80:83], v124 offset:12288
    ds_read_b64_tr_b16 a[36:37], v121 offset:16928
    v_mfma_f32_16x16x32_bf16 v[152:155], a[4:7], a[64:67], v[152:155]
    ds_read_b64_tr_b16 a[38:39], v121 offset:25376
    ds_read_b64_tr_b16 a[40:41], v121 offset:16960
    v_mfma_f32_16x16x32_bf16 v[184:187], a[4:7], a[68:71], v[184:187]
    buffer_load_dwordx4 v113, s[32:35], s63 offen offset:1056 lds
    v_mfma_f32_16x16x32_bf16 v[216:219], a[4:7], a[72:75], v[216:219]
    ds_read_b64_tr_b16 a[42:43], v121 offset:25408
    ds_read_b64_tr_b16 a[44:45], v121 offset:16992
    v_mfma_f32_16x16x32_bf16 v[156:159], a[8:11], a[64:67], v[156:159]
    ds_read_b64_tr_b16 a[46:47], v121 offset:25440
    ds_read_b64_tr_b16 a[48:49], v122 offset:16896
    v_mfma_f32_16x16x32_bf16 v[188:191], a[8:11], a[68:71], v[188:191]
    ds_read_b64_tr_b16 a[50:51], v122 offset:25344
    ds_read_b64_tr_b16 a[52:53], v122 offset:16928
    v_mfma_f32_16x16x32_bf16 v[220:223], a[8:11], a[72:75], v[220:223]
    buffer_load_dwordx4 v114, s[32:35], s63 offen offset:2112 lds
    v_mfma_f32_16x16x32_bf16 v[160:163], a[12:15], a[64:67], v[160:163]
    ds_read_b64_tr_b16 a[54:55], v122 offset:25376
    ds_read_b64_tr_b16 a[56:57], v122 offset:16960
    v_mfma_f32_16x16x32_bf16 v[192:195], a[12:15], a[68:71], v[192:195]
    ds_read_b64_tr_b16 a[58:59], v122 offset:25408
    ds_read_b64_tr_b16 a[60:61], v122 offset:16992
    v_mfma_f32_16x16x32_bf16 v[224:227], a[12:15], a[72:75], v[224:227]
    ds_read_b64_tr_b16 a[62:63], v122 offset:25440
    v_mfma_f32_16x16x32_bf16 v[164:167], a[16:19], a[64:67], v[164:167]
    buffer_load_dwordx4 v115, s[32:35], s63 offen offset:3168 lds
    v_mfma_f32_16x16x32_bf16 v[196:199], a[16:19], a[68:71], v[196:199]
    v_mfma_f32_16x16x32_bf16 v[168:171], a[20:23], a[64:67], v[168:171]
    v_mfma_f32_16x16x32_bf16 v[200:203], a[20:23], a[68:71], v[200:203]
    v_mfma_f32_16x16x32_bf16 v[172:175], a[24:27], a[64:67], v[172:175]
    v_mfma_f32_16x16x32_bf16 v[204:207], a[24:27], a[68:71], v[204:207]
    v_mfma_f32_16x16x32_bf16 v[176:179], a[28:31], a[64:67], v[176:179]
    v_mfma_f32_16x16x32_bf16 v[208:211], a[28:31], a[68:71], v[208:211]
    s_waitcnt vmcnt(4) lgkmcnt(0)
    s_barrier
    s_add_u32 m0, s89, 16896
    v_mfma_f32_16x16x32_bf16 v[148:151], a[32:35], a[76:79], v[148:151]
    buffer_load_dwordx4 v112, s[32:35], s64 offen lds
    v_mfma_f32_16x16x32_bf16 v[180:183], a[32:35], a[80:83], v[180:183]
    ds_read_b128 a[64:67], v123 offset:20480
    ds_read_b64_tr_b16 a[0:1], v121 offset:33792
    v_mfma_f32_16x16x32_bf16 v[212:215], a[32:35], a[84:87], v[212:215]
    ds_read_b64_tr_b16 a[2:3], v121 offset:42240
    ds_read_b128 a[68:71], v123 offset:22528
    v_mfma_f32_16x16x32_bf16 v[152:155], a[36:39], a[76:79], v[152:155]
    ds_read_b64_tr_b16 a[4:5], v121 offset:33824
    ds_read_b64_tr_b16 a[6:7], v121 offset:42272
    v_mfma_f32_16x16x32_bf16 v[184:187], a[36:39], a[80:83], v[184:187]
    buffer_load_dwordx4 v113, s[32:35], s64 offen offset:1056 lds
    v_mfma_f32_16x16x32_bf16 v[216:219], a[36:39], a[84:87], v[216:219]
    ds_read_b128 a[72:75], v125 offset:24576
    ds_read_b64_tr_b16 a[8:9], v121 offset:33856
    v_mfma_f32_16x16x32_bf16 v[156:159], a[40:43], a[76:79], v[156:159]
    ds_read_b64_tr_b16 a[10:11], v121 offset:42304
    ds_read_b64_tr_b16 a[12:13], v121 offset:33888
    v_mfma_f32_16x16x32_bf16 v[188:191], a[40:43], a[80:83], v[188:191]
    ds_read_b64_tr_b16 a[14:15], v121 offset:42336
    ds_read_b64_tr_b16 a[16:17], v122 offset:33792
    v_mfma_f32_16x16x32_bf16 v[220:223], a[40:43], a[84:87], v[220:223]
    buffer_load_dwordx4 v114, s[32:35], s64 offen offset:2112 lds
    v_mfma_f32_16x16x32_bf16 v[160:163], a[44:47], a[76:79], v[160:163]
    ds_read_b64_tr_b16 a[18:19], v122 offset:42240
    ds_read_b64_tr_b16 a[20:21], v122 offset:33824
    v_mfma_f32_16x16x32_bf16 v[192:195], a[44:47], a[80:83], v[192:195]
    ds_read_b64_tr_b16 a[22:23], v122 offset:42272
    ds_read_b64_tr_b16 a[24:25], v122 offset:33856
    v_mfma_f32_16x16x32_bf16 v[224:227], a[44:47], a[84:87], v[224:227]
    ds_read_b64_tr_b16 a[26:27], v122 offset:42304
    ds_read_b64_tr_b16 a[28:29], v122 offset:33888
    v_mfma_f32_16x16x32_bf16 v[164:167], a[48:51], a[76:79], v[164:167]
    buffer_load_dwordx4 v115, s[32:35], s64 offen offset:3168 lds
    v_mfma_f32_16x16x32_bf16 v[196:199], a[48:51], a[80:83], v[196:199]
    ds_read_b64_tr_b16 a[30:31], v122 offset:42336
    ds_read_b128 a[84:87], v126 offset:24576
    v_mfma_f32_16x16x32_bf16 v[168:171], a[52:55], a[76:79], v[168:171]
    v_mfma_f32_16x16x32_bf16 v[200:203], a[52:55], a[80:83], v[200:203]
    v_mfma_f32_16x16x32_bf16 v[172:175], a[56:59], a[76:79], v[172:175]
    v_mfma_f32_16x16x32_bf16 v[204:207], a[56:59], a[80:83], v[204:207]
    v_mfma_f32_16x16x32_bf16 v[176:179], a[60:63], a[76:79], v[176:179]
    ds_read_b128 a[76:79], v124 offset:20480
    v_mfma_f32_16x16x32_bf16 v[208:211], a[60:63], a[80:83], v[208:211]
    s_waitcnt vmcnt(4) lgkmcnt(1)
    s_barrier
    s_add_u32 m0, s89, 33792
    v_mfma_f32_16x16x32_bf16 v[148:151], a[0:3], a[64:67], v[148:151]
    buffer_load_dwordx4 v112, s[32:35], s65 offen lds
    v_mfma_f32_16x16x32_bf16 v[180:183], a[0:3], a[68:71], v[180:183]
    ds_read_b64_tr_b16 a[32:33], v121 offset:0
    ds_read_b64_tr_b16 a[34:35], v121 offset:8448
    v_mfma_f32_16x16x32_bf16 v[212:215], a[0:3], a[72:75], v[212:215]
    ds_read_b128 a[80:83], v124 offset:22528
    ds_read_b64_tr_b16 a[36:37], v121 offset:32
    v_mfma_f32_16x16x32_bf16 v[152:155], a[4:7], a[64:67], v[152:155]
    buffer_load_dwordx4 v113, s[32:35], s65 offen offset:1056 lds
    v_mfma_f32_16x16x32_bf16 v[184:187], a[4:7], a[68:71], v[184:187]
    ds_read_b64_tr_b16 a[38:39], v121 offset:8480
    ds_read_b64_tr_b16 a[40:41], v121 offset:64
    v_mfma_f32_16x16x32_bf16 v[216:219], a[4:7], a[72:75], v[216:219]
    ds_read_b64_tr_b16 a[42:43], v121 offset:8512
    ds_read_b64_tr_b16 a[44:45], v121 offset:96
    v_mfma_f32_16x16x32_bf16 v[156:159], a[8:11], a[64:67], v[156:159]
    buffer_load_dwordx4 v114, s[32:35], s65 offen offset:2112 lds
    v_mfma_f32_16x16x32_bf16 v[188:191], a[8:11], a[68:71], v[188:191]
    ds_read_b64_tr_b16 a[46:47], v121 offset:8544
    ds_read_b64_tr_b16 a[48:49], v122 offset:0
    v_mfma_f32_16x16x32_bf16 v[220:223], a[8:11], a[72:75], v[220:223]
    ds_read_b64_tr_b16 a[50:51], v122 offset:8448
    ds_read_b64_tr_b16 a[52:53], v122 offset:32
    v_mfma_f32_16x16x32_bf16 v[160:163], a[12:15], a[64:67], v[160:163]
    buffer_load_dwordx4 v115, s[32:35], s65 offen offset:3168 lds
    v_mfma_f32_16x16x32_bf16 v[192:195], a[12:15], a[68:71], v[192:195]
    ds_read_b64_tr_b16 a[54:55], v122 offset:8480
    ds_read_b64_tr_b16 a[56:57], v122 offset:64
    v_mfma_f32_16x16x32_bf16 v[224:227], a[12:15], a[72:75], v[224:227]
    ds_read_b64_tr_b16 a[58:59], v122 offset:8512
    ds_read_b64_tr_b16 a[60:61], v122 offset:96
    v_mfma_f32_16x16x32_bf16 v[164:167], a[16:19], a[64:67], v[164:167]
    ds_read_b64_tr_b16 a[62:63], v122 offset:8544
    s_add_u32 m0, s89, 130048
    v_mfma_f32_16x16x32_bf16 v[196:199], a[16:19], a[68:71], v[196:199]
    buffer_load_dwordx4 v10, s[28:31], s80 offen nt lds
    v_mfma_f32_16x16x32_bf16 v[168:171], a[20:23], a[64:67], v[168:171]
    ds_read_b128 a[72:75], v125 offset:34816
    s_add_u32 m0, s89, 130848
    v_mfma_f32_16x16x32_bf16 v[200:203], a[20:23], a[68:71], v[200:203]
    buffer_load_dwordx4 v10, s[28:31], s80 offen offset:256 nt lds
    v_mfma_f32_16x16x32_bf16 v[172:175], a[24:27], a[64:67], v[172:175]
    s_add_u32 m0, s89, 131648
    v_mfma_f32_16x16x32_bf16 v[204:207], a[24:27], a[68:71], v[204:207]
    buffer_load_dwordx4 v10, s[28:31], s80 offen offset:512 nt lds
    s_add_u32 m0, s89, 132448
    v_mfma_f32_16x16x32_bf16 v[176:179], a[28:31], a[64:67], v[176:179]
    buffer_load_dwordx4 v10, s[28:31], s80 offen offset:768 nt lds
    v_mfma_f32_16x16x32_bf16 v[208:211], a[28:31], a[68:71], v[208:211]
    s_waitcnt vmcnt(8) lgkmcnt(0)
    s_barrier
    s_add_u32 m0, s88, 113408
    v_mfma_f32_16x16x32_bf16 v[148:151], a[32:35], a[76:79], v[148:151]
    ds_read_b64_tr_b16 a[0:1], v121 offset:16896
    ds_read_b128 a[68:71], v123 offset:32768
    v_mfma_f32_16x16x32_bf16 v[180:183], a[32:35], a[80:83], v[180:183]
    ds_read_b64_tr_b16 a[2:3], v121 offset:25344
    ds_read_b64_tr_b16 a[4:5], v121 offset:16928
    v_mfma_f32_16x16x32_bf16 v[212:215], a[32:35], a[84:87], v[212:215]
    ds_read_b64_tr_b16 a[6:7], v121 offset:25376
    ds_read_b64_tr_b16 a[8:9], v121 offset:16960
    v_mfma_f32_16x16x32_bf16 v[152:155], a[36:39], a[76:79], v[152:155]
    ds_read_b64_tr_b16 a[10:11], v121 offset:25408
    ds_read_b64_tr_b16 a[12:13], v121 offset:16992
    v_mfma_f32_16x16x32_bf16 v[184:187], a[36:39], a[80:83], v[184:187]
    ds_read_b64_tr_b16 a[14:15], v121 offset:25440
    ds_read_b64_tr_b16 a[16:17], v122 offset:16896
    v_mfma_f32_16x16x32_bf16 v[216:219], a[36:39], a[84:87], v[216:219]
    ds_read_b64_tr_b16 a[18:19], v122 offset:25344
    ds_read_b64_tr_b16 a[20:21], v122 offset:16928
    v_mfma_f32_16x16x32_bf16 v[156:159], a[40:43], a[76:79], v[156:159]
    ds_read_b64_tr_b16 a[22:23], v122 offset:25376
    ds_read_b64_tr_b16 a[24:25], v122 offset:16960
    v_mfma_f32_16x16x32_bf16 v[188:191], a[40:43], a[80:83], v[188:191]
    buffer_load_dwordx4 v9, s[24:27], s81 offen nt lds
    v_mfma_f32_16x16x32_bf16 v[220:223], a[40:43], a[84:87], v[220:223]
    ds_read_b64_tr_b16 a[26:27], v122 offset:25408
    ds_read_b64_tr_b16 a[28:29], v122 offset:16992
    v_mfma_f32_16x16x32_bf16 v[160:163], a[44:47], a[76:79], v[160:163]
    ds_read_b128 a[64:67], v123 offset:30720
    ds_read_b64_tr_b16 a[30:31], v122 offset:25440
    v_mfma_f32_16x16x32_bf16 v[192:195], a[44:47], a[80:83], v[192:195]
    s_add_u32 m0, s88, 115232
    s_and_b32 s9, s94, 1073741824
    v_mfma_f32_16x16x32_bf16 v[224:227], a[44:47], a[84:87], v[224:227]
    buffer_load_dwordx4 v9, s[24:27], s81 offen offset:256 nt lds
    v_mfma_f32_16x16x32_bf16 v[164:167], a[48:51], a[76:79], v[164:167]
    ds_read_b128 a[84:87], v126 offset:34816
    v_lshl_add_u32 v253, v0, 12, s9
    v_mfma_f32_16x16x32_bf16 v[196:199], a[48:51], a[80:83], v[196:199]
    s_add_u32 m0, s88, 117056
    s_lshl_b32 s9, s44, 4
    v_mfma_f32_16x16x32_bf16 v[168:171], a[52:55], a[76:79], v[168:171]
    buffer_load_dwordx4 v9, s[24:27], s81 offen offset:512 nt lds
    v_mfma_f32_16x16x32_bf16 v[200:203], a[52:55], a[80:83], v[200:203]
    s_add_u32 m0, s88, 118880
    v_mfma_f32_16x16x32_bf16 v[172:175], a[56:59], a[76:79], v[172:175]
    buffer_load_dwordx4 v9, s[24:27], s81 offen offset:768 nt lds
    v_mfma_f32_16x16x32_bf16 v[204:207], a[56:59], a[80:83], v[204:207]
    buffer_atomic_or_x2 v[254:255], v253, s[16:19], s9 offen sc1
    v_mfma_f32_16x16x32_bf16 v[176:179], a[60:63], a[76:79], v[176:179]
    ds_read_b128 a[76:79], v124 offset:30720
    v_mfma_f32_16x16x32_bf16 v[208:211], a[60:63], a[80:83], v[208:211]
    s_waitcnt vmcnt(9) lgkmcnt(1)
    s_barrier
    v_mfma_f32_16x16x32_bf16 v[180:183], a[0:3], a[68:71], v[180:183]
    ds_read_b64_tr_b16 a[32:33], v121 offset:33792
    ds_read_b64_tr_b16 a[34:35], v121 offset:42240
    v_mfma_f32_16x16x32_bf16 v[184:187], a[4:7], a[68:71], v[184:187]
    ds_read_b64_tr_b16 a[36:37], v121 offset:33824
    ds_read_b64_tr_b16 a[38:39], v121 offset:42272
    v_mfma_f32_16x16x32_bf16 v[188:191], a[8:11], a[68:71], v[188:191]
    ds_read_b64_tr_b16 a[40:41], v121 offset:33856
    ds_read_b64_tr_b16 a[42:43], v121 offset:42304
    v_mfma_f32_16x16x32_bf16 v[192:195], a[12:15], a[68:71], v[192:195]
    ds_read_b64_tr_b16 a[44:45], v121 offset:33888
    ds_read_b64_tr_b16 a[46:47], v121 offset:42336
    v_mfma_f32_16x16x32_bf16 v[196:199], a[16:19], a[68:71], v[196:199]
    ds_read_b64_tr_b16 a[48:49], v122 offset:33792
    ds_read_b64_tr_b16 a[50:51], v122 offset:42240
    v_mfma_f32_16x16x32_bf16 v[200:203], a[20:23], a[68:71], v[200:203]
    ds_read_b64_tr_b16 a[52:53], v122 offset:33824
    ds_read_b64_tr_b16 a[54:55], v122 offset:42272
    v_mfma_f32_16x16x32_bf16 v[204:207], a[24:27], a[68:71], v[204:207]
    ds_read_b64_tr_b16 a[56:57], v122 offset:33856
    ds_read_b64_tr_b16 a[58:59], v122 offset:42304
    v_mfma_f32_16x16x32_bf16 v[208:211], a[28:31], a[68:71], v[208:211]
    ds_read_b64_tr_b16 a[60:61], v122 offset:33888
    ds_read_b64_tr_b16 a[62:63], v122 offset:42336
    v_mfma_f32_16x16x32_bf16 v[212:215], a[0:3], a[72:75], v[212:215]
    ds_read_b128 a[80:83], v124 offset:32768
    s_waitcnt lgkmcnt(7)
    v_mfma_f32_16x16x32_bf16 v[212:215], a[32:35], a[84:87], v[212:215]
    s_nop 2
    v_mfma_f32_16x16x32_bf16 v[216:219], a[4:7], a[72:75], v[216:219]
    s_nop 1
    v_mfma_f32_16x16x32_bf16 v[216:219], a[36:39], a[84:87], v[216:219]
    v_mfma_f32_16x16x32_bf16 v[220:223], a[8:11], a[72:75], v[220:223]
    v_mul_f32 v212, s95, v212
    v_mul_f32 v214, s95, v214
    v_mul_f32 v215, s95, v215
    v_mfma_f32_16x16x32_bf16 v[220:223], a[40:43], a[84:87], v[220:223]
    v_mul_f32 v213, s95, v213
    v_cvt_pk_bf16_f32 v60, v212, v213
    v_cvt_pk_bf16_f32 v61, v214, v215
    v_mfma_f32_16x16x32_bf16 v[224:227], a[12:15], a[72:75], v[224:227]
    v_mul_f32 v216, s95, v216
    v_mul_f32 v217, s95, v217
    v_mul_f32 v218, s95, v218
    v_cvt_pk_bf16_f32 v62, v216, v217
    v_mfma_f32_16x16x32_bf16 v[224:227], a[44:47], a[84:87], v[224:227]
    v_mul_f32 v219, s95, v219
    v_cvt_pk_bf16_f32 v63, v218, v219
    v_mfma_f32_16x16x32_bf16 v[148:151], a[0:3], a[64:67], v[148:151]
    v_permlane16_swap_b32 v60, v62
    v_mul_f32 v220, s95, v220
    v_mul_f32 v222, s95, v222
    v_mul_f32 v223, s95, v223
    v_cvt_pk_bf16_f32 v65, v222, v223
    v_mfma_f32_16x16x32_bf16 v[148:151], a[32:35], a[76:79], v[148:151]
    v_permlane16_swap_b32 v61, v63
    v_mul_f32 v221, s95, v221
    v_cvt_pk_bf16_f32 v64, v220, v221
    v_mfma_f32_16x16x32_bf16 v[152:155], a[4:7], a[64:67], v[152:155]
    v_mul_f32 v224, s95, v224
    v_mul_f32 v225, s95, v225
    v_mul_f32 v226, s95, v226
    v_mul_f32 v227, s95, v227
    v_cvt_pk_bf16_f32 v66, v224, v225
    v_cvt_pk_bf16_f32 v67, v226, v227
    v_mfma_f32_16x16x32_bf16 v[152:155], a[36:39], a[76:79], v[152:155]
    s_nop 0
    v_permlane16_swap_b32 v65, v67
    v_mfma_f32_16x16x32_bf16 v[156:159], a[8:11], a[64:67], v[156:159]
    v_permlane16_swap_b32 v64, v66
    v_mul_f32 v149, s95, v149
    v_mul_f32 v151, s95, v151
    v_mfma_f32_16x16x32_bf16 v[156:159], a[40:43], a[76:79], v[156:159]
    ds_write_b128 v140, v[60:63] offset:0
    v_mul_f32 v148, s95, v148
    v_mul_f32 v150, s95, v150
    v_mfma_f32_16x16x32_bf16 v[160:163], a[12:15], a[64:67], v[160:163]
    ds_write_b128 v140, v[64:67] offset:1024
    v_mul_f32 v152, s95, v152
    v_mul_f32 v154, s95, v154
    v_mfma_f32_16x16x32_bf16 v[160:163], a[44:47], a[76:79], v[160:163]
    v_cvt_pk_bf16_f32 v28, v148, v149
    v_mul_f32 v153, s95, v153
    v_mul_f32 v155, s95, v155
    v_cvt_pk_bf16_f32 v30, v152, v153
    v_mfma_f32_16x16x32_bf16 v[164:167], a[16:19], a[64:67], v[164:167]
    v_cvt_pk_bf16_f32 v29, v150, v151
    v_mul_f32 v157, s95, v157
    v_mul_f32 v159, s95, v159
    v_mfma_f32_16x16x32_bf16 v[164:167], a[48:51], a[76:79], v[164:167]
    v_cvt_pk_bf16_f32 v31, v154, v155
    v_mul_f32 v156, s95, v156
    v_mul_f32 v158, s95, v158
    v_cvt_pk_bf16_f32 v32, v156, v157
    v_mfma_f32_16x16x32_bf16 v[168:171], a[20:23], a[64:67], v[168:171]
    s_waitcnt lgkmcnt(0)
    v_cvt_pk_bf16_f32 v33, v158, v159
    v_mul_f32 v161, s95, v161
    v_mul_f32 v162, s95, v162
    v_mul_f32 v163, s95, v163
    v_cvt_pk_bf16_f32 v35, v162, v163
    v_mfma_f32_16x16x32_bf16 v[168:171], a[52:55], a[76:79], v[168:171]
    v_permlane16_swap_b32 v28, v30
    v_mul_f32 v160, s95, v160
    v_cvt_pk_bf16_f32 v34, v160, v161
    v_mfma_f32_16x16x32_bf16 v[172:175], a[24:27], a[64:67], v[172:175]
    v_permlane16_swap_b32 v29, v31
    v_mul_f32 v164, s95, v164
    v_mul_f32 v165, s95, v165
    v_mul_f32 v166, s95, v166
    v_cvt_pk_bf16_f32 v36, v164, v165
    v_mfma_f32_16x16x32_bf16 v[172:175], a[56:59], a[76:79], v[172:175]
    s_barrier
    s_add_u32 m0, s89, 146944
    v_mfma_f32_16x16x32_bf16 v[176:179], a[28:31], a[64:67], v[176:179]
    ds_read_b128 a[96:99], v1 offset:0
    ds_read_b128 a[100:103], v1 offset:64
    ds_read_b128 a[104:107], v2 offset:0
    ds_read_b128 a[108:111], v2 offset:64
    v_permlane16_swap_b32 v32, v34
    v_mul_f32 v167, s95, v167
    v_cvt_pk_bf16_f32 v37, v166, v167
    v_mul_f32 v168, s95, v168
    v_mul_f32 v169, s95, v169
    v_mul_f32 v170, s95, v170
    v_mul_f32 v171, s95, v171
    v_cvt_pk_bf16_f32 v38, v168, v169
    v_cvt_pk_bf16_f32 v39, v170, v171
    v_mfma_f32_16x16x32_bf16 v[176:179], a[60:63], a[76:79], v[176:179]
    ds_read_b128 a[112:115], v1 offset:256
    v_permlane16_swap_b32 v33, v35
    v_mul_f32 v172, s95, v172
    v_mul_f32 v174, s95, v174
    v_mfma_f32_16x16x32_bf16 v[180:183], a[32:35], a[80:83], v[180:183]
    ds_read_b128 a[116:119], v1 offset:320
    ds_read_b128 a[124:127], v2 offset:320
    v_mul_f32 v173, s95, v173
    v_mul_f32 v175, s95, v175
    v_cvt_pk_bf16_f32 v41, v174, v175
    v_mfma_f32_16x16x32_bf16 v[184:187], a[36:39], a[80:83], v[184:187]
    v_permlane16_swap_b32 v36, v38
    v_cvt_pk_bf16_f32 v40, v172, v173
    v_mfma_f32_16x16x32_bf16 v[188:191], a[40:43], a[80:83], v[188:191]
    buffer_load_dwordx4 v10, s[28:31], s81 offen nt lds
    ds_read_b128 a[120:123], v2 offset:256
    v_permlane16_swap_b32 v37, v39
    v_mul_f32 v176, s95, v176
    v_mul_f32 v177, s95, v177
    v_mul_f32 v178, s95, v178
    v_mul_f32 v179, s95, v179
    v_mfma_f32_16x16x32_bf16 v[192:195], a[44:47], a[80:83], v[192:195]
    ds_read_b128 v[68:71], v141 offset:0
    v_cvt_pk_bf16_f32 v42, v176, v177
    v_cvt_pk_bf16_f32 v43, v178, v179
    v_mul_f32 v180, s95, v180
    v_mul_f32 v181, s95, v181
    v_mul_f32 v183, s95, v183
    v_cvt_pk_bf16_f32 v44, v180, v181
    v_mfma_f32_16x16x32_bf16 v[196:199], a[48:51], a[80:83], v[196:199]
    ds_read_b128 v[72:75], v141 offset:1024
    s_add_u32 m0, s89, 147744
    v_mul_f32 v182, s95, v182
    v_cvt_pk_bf16_f32 v45, v182, v183
    v_mul_f32 v184, s95, v184
    v_mul_f32 v186, s95, v186
    v_mul_f32 v187, s95, v187
    v_mfma_f32_16x16x32_bf16 v[200:203], a[52:55], a[80:83], v[200:203]
    buffer_load_dwordx4 v10, s[28:31], s81 offen offset:256 nt lds
    v_mul_f32 v185, s95, v185
    v_cvt_pk_bf16_f32 v47, v186, v187
    v_mul_f32 v188, s95, v188
    v_mul_f32 v189, s95, v189
    v_mul_f32 v190, s95, v190
    v_mul_f32 v191, s95, v191
    v_cvt_pk_bf16_f32 v48, v188, v189
    v_mfma_f32_16x16x32_bf16 v[204:207], a[56:59], a[80:83], v[204:207]
    s_add_u32 m0, s89, 148544
    v_permlane16_swap_b32 v40, v42
    v_cvt_pk_bf16_f32 v49, v190, v191
    v_mul_f32 v192, s95, v192
    v_mul_f32 v193, s95, v193
    v_mul_f32 v194, s95, v194
    v_mul_f32 v195, s95, v195
    v_cvt_pk_bf16_f32 v50, v192, v193
    v_mfma_f32_16x16x32_bf16 v[208:211], a[60:63], a[80:83], v[208:211]
    s_waitcnt lgkmcnt(1)
    v_permlane16_swap_b32 v41, v43
    v_cvt_pk_bf16_f32 v51, v194, v195
    v_mul_f32 v196, s95, v196
    v_mul_f32 v197, s95, v197
    v_mul_f32 v198, s95, v198
    v_mul_f32 v199, s95, v199
    v_cvt_pk_bf16_f32 v52, v196, v197
    v_mfma_f32_16x16x32_bf16 v[88:91], a[96:99], v[28:31], v[76:79]
    v_cvt_pk_bf16_f32 v46, v184, v185
    v_cvt_pk_bf16_f32 v53, v198, v199
    v_mul_f32 v200, s95, v200
    v_mul_f32 v201, s95, v201
    v_mul_f32 v202, s95, v202
    v_mul_f32 v203, s95, v203
    v_cvt_pk_bf16_f32 v54, v200, v201
    v_mfma_f32_16x16x32_bf16 v[88:91], a[100:103], v[32:35], v[88:91]
    v_cvt_pk_bf16_f32 v55, v202, v203
    v_mul_f32 v204, s95, v204
    v_mul_f32 v205, s95, v205
    v_mul_f32 v206, s95, v206
    v_mul_f32 v207, s95, v207
    v_cvt_pk_bf16_f32 v56, v204, v205
    v_mfma_f32_16x16x32_bf16 v[88:91], a[104:107], v[36:39], v[88:91]
    buffer_load_dwordx4 v10, s[28:31], s81 offen offset:512 nt lds
    v_cvt_pk_bf16_f32 v57, v206, v207
    v_mul_f32 v210, s95, v210
    v_mul_f32 v211, s95, v211
    v_cvt_pk_bf16_f32 v59, v210, v211
    v_mfma_f32_16x16x32_bf16 v[88:91], a[108:111], v[40:43], v[88:91]
    s_add_u32 m0, s89, 149344
    v_permlane16_swap_b32 v44, v46
    v_mfma_f32_16x16x32_bf16 v[92:95], a[112:115], v[28:31], v[76:79]
    v_permlane16_swap_b32 v45, v47
    v_mfma_f32_16x16x32_bf16 v[92:95], a[116:119], v[32:35], v[92:95]
    buffer_load_dwordx4 v10, s[28:31], s81 offen offset:768 nt lds
    v_permlane16_swap_b32 v48, v50
    v_mfma_f32_16x16x32_bf16 v[92:95], a[120:123], v[36:39], v[92:95]
    v_permlane16_swap_b32 v49, v51
    v_mul_f32 v208, s95, v208
    v_mfma_f32_16x16x32_bf16 v[92:95], a[124:127], v[40:43], v[92:95]
    v_permlane16_swap_b32 v52, v54
    v_mul_f32 v209, s95, v209
    v_mfma_f32_16x16x32_bf16 v[104:107], a[96:99], v[60:63], v[84:87]
    v_permlane16_swap_b32 v53, v55
    v_cvt_pk_bf16_f32 v58, v208, v209
    v_mfma_f32_16x16x32_bf16 v[104:107], a[100:103], v[64:67], v[104:107]
    s_nop 0
    v_permlane16_swap_b32 v56, v58
    v_mfma_f32_16x16x32_bf16 v[104:107], a[104:107], v[68:71], v[104:107]
    s_waitcnt lgkmcnt(0)
    v_permlane16_swap_b32 v57, v59
    v_mfma_f32_16x16x32_bf16 v[104:107], a[108:111], v[72:75], v[104:107]
    ds_read_b128 a[128:131], v3 offset:0
    ds_read_b128 a[132:135], v3 offset:64
    v_mfma_f32_16x16x32_bf16 v[108:111], a[112:115], v[60:63], v[84:87]
    ds_read_b128 a[136:139], v4 offset:0
    ds_read_b128 a[140:143], v4 offset:64
    v_mfma_f32_16x16x32_bf16 v[108:111], a[116:119], v[64:67], v[108:111]
    ds_read_b128 a[144:147], v3 offset:256
    ds_read_b128 a[148:151], v3 offset:320
    v_mfma_f32_16x16x32_bf16 v[108:111], a[120:123], v[68:71], v[108:111]
    ds_read_b128 a[152:155], v4 offset:256
    ds_read_b128 a[156:159], v4 offset:320
    v_mfma_f32_16x16x32_bf16 v[108:111], a[124:127], v[72:75], v[108:111]
    v_exp_f32 v88, v88
    v_mfma_f32_16x16x32_bf16 v[96:99], a[96:99], v[44:47], v[80:83]
    v_exp_f32 v89, v89
    v_mfma_f32_16x16x32_bf16 v[96:99], a[100:103], v[48:51], v[96:99]
    v_exp_f32 v90, v90
    v_mfma_f32_16x16x32_bf16 v[96:99], a[104:107], v[52:55], v[96:99]
    v_exp_f32 v91, v91
    v_mfma_f32_16x16x32_bf16 v[96:99], a[108:111], v[56:59], v[96:99]
    v_exp_f32 v92, v92
    v_mfma_f32_16x16x32_bf16 v[100:103], a[112:115], v[44:47], v[80:83]
    v_exp_f32 v93, v93
    v_mfma_f32_16x16x32_bf16 v[100:103], a[116:119], v[48:51], v[100:103]
    v_exp_f32 v94, v94
    v_mfma_f32_16x16x32_bf16 v[100:103], a[120:123], v[52:55], v[100:103]
    v_exp_f32 v95, v95
    v_mfma_f32_16x16x32_bf16 v[100:103], a[124:127], v[56:59], v[100:103]
    s_waitcnt vmcnt(9) lgkmcnt(0)
    s_barrier
    v_cvt_pk_bf16_f32 v128, v88, v89
    v_mfma_f32_16x16x32_bf16 v[112:115], a[128:131], v[28:31], v[76:79]
    ds_read_b64_tr_b16 a[160:161], v5 offset:0
    ds_read_b64_tr_b16 a[162:163], v5 offset:512
    v_mfma_f32_16x16x32_bf16 v[112:115], a[132:135], v[32:35], v[112:115]
    ds_read_b64_tr_b16 a[164:165], v5 offset:32
    ds_read_b64_tr_b16 a[166:167], v5 offset:544
    v_mfma_f32_16x16x32_bf16 v[112:115], a[136:139], v[36:39], v[112:115]
    ds_read_b64_tr_b16 a[168:169], v5 offset:64
    ds_read_b64_tr_b16 a[170:171], v5 offset:576
    v_mfma_f32_16x16x32_bf16 v[112:115], a[140:143], v[40:43], v[112:115]
    ds_read_b64_tr_b16 a[172:173], v5 offset:96
    ds_read_b64_tr_b16 a[174:175], v5 offset:608
    v_mfma_f32_16x16x32_bf16 v[116:119], a[144:147], v[28:31], v[76:79]
    ds_read_b64_tr_b16 a[176:177], v6 offset:0
    ds_read_b64_tr_b16 a[178:179], v6 offset:512
    v_mfma_f32_16x16x32_bf16 v[116:119], a[148:151], v[32:35], v[116:119]
    v_cvt_pk_bf16_f32 v129, v90, v91
    v_cvt_pk_bf16_f32 v130, v92, v93
    v_mfma_f32_16x16x32_bf16 v[116:119], a[152:155], v[36:39], v[116:119]
    ds_read_b64_tr_b16 a[180:181], v6 offset:32
    v_cvt_pk_bf16_f32 v131, v94, v95
    v_mfma_f32_16x16x32_bf16 v[116:119], a[156:159], v[40:43], v[116:119]
    ds_read_b64_tr_b16 a[182:183], v6 offset:544
    ds_read_b64_tr_b16 a[184:185], v6 offset:64
    v_mfma_f32_16x16x32_bf16 v[120:123], a[128:131], v[44:47], v[80:83]
    ds_read_b64_tr_b16 a[186:187], v6 offset:576
    ds_read_b64_tr_b16 a[188:189], v6 offset:96
    v_mfma_f32_16x16x32_bf16 v[120:123], a[132:135], v[48:51], v[120:123]
    ds_read_b64_tr_b16 a[190:191], v6 offset:608
    ds_read_b64_tr_b16 a[192:193], v7 offset:0
    v_mfma_f32_16x16x32_bf16 v[120:123], a[136:139], v[52:55], v[120:123]
    v_exp_f32 v104, v104
    v_mfma_f32_16x16x32_bf16 v[120:123], a[140:143], v[56:59], v[120:123]
    v_exp_f32 v105, v105
    v_mfma_f32_16x16x32_bf16 v[124:127], a[144:147], v[44:47], v[80:83]
    v_exp_f32 v106, v106
    v_mfma_f32_16x16x32_bf16 v[124:127], a[148:151], v[48:51], v[124:127]
    v_exp_f32 v107, v107
    v_mfma_f32_16x16x32_bf16 v[124:127], a[152:155], v[52:55], v[124:127]
    v_exp_f32 v108, v108
    v_mfma_f32_16x16x32_bf16 v[124:127], a[156:159], v[56:59], v[124:127]
    s_waitcnt vmcnt(5) lgkmcnt(0)
    s_barrier
    s_add_u32 m0, s88, 96768
    v_mfma_f32_16x16x32_bf16 v[244:247], a[224:227], v[128:131], 0
    v_exp_f32 v109, v109
    v_mfma_f32_16x16x32_bf16 v[148:151], a[160:163], v[128:131], 0
    v_exp_f32 v110, v110
    v_mfma_f32_16x16x32_bf16 v[152:155], a[164:167], v[128:131], 0
    buffer_load_dwordx4 v9, s[24:27], s82 offen nt lds
    s_add_u32 m0, s88, 98592
    v_exp_f32 v111, v111
    v_mfma_f32_16x16x32_bf16 v[156:159], a[168:171], v[128:131], 0
    buffer_load_dwordx4 v9, s[24:27], s82 offen offset:256 nt lds
    v_mfma_f32_16x16x32_bf16 v[160:163], a[172:175], v[128:131], 0
    s_add_u32 m0, s88, 100416
    v_cvt_pk_bf16_f32 v136, v104, v105
    v_cvt_pk_bf16_f32 v137, v106, v107
    v_mfma_f32_16x16x32_bf16 v[164:167], a[176:179], v[128:131], 0
    v_cvt_pk_bf16_f32 v138, v108, v109
    v_cvt_pk_bf16_f32 v139, v110, v111
    v_mfma_f32_16x16x32_bf16 v[168:171], a[180:183], v[128:131], 0
    buffer_load_dwordx4 v9, s[24:27], s82 offen offset:512 nt lds
    v_mfma_f32_16x16x32_bf16 v[172:175], a[184:187], v[128:131], 0
    s_add_u32 m0, s88, 102240
    v_exp_f32 v96, v96
    v_mfma_f32_16x16x32_bf16 v[176:179], a[188:191], v[128:131], 0
    v_exp_f32 v97, v97
    v_mfma_f32_16x16x32_bf16 v[252:255], a[224:227], v[136:139], 0
    v_exp_f32 v98, v98
    v_mfma_f32_16x16x32_bf16 v[212:215], a[160:163], v[136:139], 0
    v_exp_f32 v99, v99
    v_mfma_f32_16x16x32_bf16 v[216:219], a[164:167], v[136:139], 0
    buffer_load_dwordx4 v9, s[24:27], s82 offen offset:768 nt lds
    v_exp_f32 v100, v100
    v_mfma_f32_16x16x32_bf16 v[220:223], a[168:171], v[136:139], 0
    v_exp_f32 v101, v101
    v_mfma_f32_16x16x32_bf16 v[224:227], a[172:175], v[136:139], 0
    v_exp_f32 v102, v102
    v_mfma_f32_16x16x32_bf16 v[228:231], a[176:179], v[136:139], 0
    v_exp_f32 v103, v103
    v_mfma_f32_16x16x32_bf16 v[232:235], a[180:183], v[136:139], 0
    v_cvt_pk_bf16_f32 v132, v96, v97
    v_cvt_pk_bf16_f32 v133, v98, v99
    v_mfma_f32_16x16x32_bf16 v[236:239], a[184:187], v[136:139], 0
    v_cvt_pk_bf16_f32 v134, v100, v101
    v_cvt_pk_bf16_f32 v135, v102, v103
    v_mfma_f32_16x16x32_bf16 v[240:243], a[188:191], v[136:139], 0
    ds_read_b128 a[96:99], v1 offset:16640
    ds_read_b128 a[100:103], v1 offset:16704
    v_mfma_f32_16x16x32_bf16 v[248:251], a[224:227], v[132:135], 0
    v_exp_f32 v112, v112
    v_mfma_f32_16x16x32_bf16 v[180:183], a[160:163], v[132:135], 0
    ds_read_b128 a[104:107], v2 offset:16640
    ds_read_b128 a[108:111], v2 offset:16704
    v_mfma_f32_16x16x32_bf16 v[184:187], a[164:167], v[132:135], 0
    v_exp_f32 v113, v113
    v_mfma_f32_16x16x32_bf16 v[188:191], a[168:171], v[132:135], 0
    ds_read_b128 a[112:115], v1 offset:16896
    ds_read_b128 a[116:119], v1 offset:16960
    v_mfma_f32_16x16x32_bf16 v[192:195], a[172:175], v[132:135], 0
    v_exp_f32 v114, v114
    v_mfma_f32_16x16x32_bf16 v[196:199], a[176:179], v[132:135], 0
    ds_read_b128 a[120:123], v2 offset:16896
    ds_read_b128 a[124:127], v2 offset:16960
    v_mfma_f32_16x16x32_bf16 v[200:203], a[180:183], v[132:135], 0
    v_exp_f32 v115, v115
    v_mfma_f32_16x16x32_bf16 v[204:207], a[184:187], v[132:135], 0
    ds_read_b64_tr_b16 a[194:195], v7 offset:512
    ds_read_b64_tr_b16 a[196:197], v7 offset:32
    v_mfma_f32_16x16x32_bf16 v[208:211], a[188:191], v[132:135], 0
    s_waitcnt lgkmcnt(4)
    v_exp_f32 v116, v116
    v_mfma_f32_16x16x32_bf16 v[88:91], a[96:99], v[28:31], v[76:79]
    ds_read_b64_tr_b16 a[198:199], v7 offset:544
    ds_read_b64_tr_b16 a[200:201], v7 offset:64
    v_mfma_f32_16x16x32_bf16 v[88:91], a[100:103], v[32:35], v[88:91]
    v_exp_f32 v117, v117
    v_mfma_f32_16x16x32_bf16 v[88:91], a[104:107], v[36:39], v[88:91]
    ds_read_b64_tr_b16 a[202:203], v7 offset:576
    ds_read_b64_tr_b16 a[204:205], v7 offset:96
    v_mfma_f32_16x16x32_bf16 v[88:91], a[108:111], v[40:43], v[88:91]
    v_exp_f32 v118, v118
    v_mfma_f32_16x16x32_bf16 v[92:95], a[112:115], v[28:31], v[76:79]
    ds_read_b64_tr_b16 a[206:207], v7 offset:608
    ds_read_b64_tr_b16 a[208:209], v8 offset:0
    v_mfma_f32_16x16x32_bf16 v[92:95], a[116:119], v[32:35], v[92:95]
    s_waitcnt lgkmcnt(4)
    v_exp_f32 v119, v119
    v_mfma_f32_16x16x32_bf16 v[92:95], a[120:123], v[36:39], v[92:95]
    ds_read_b64_tr_b16 a[210:211], v8 offset:512
    ds_read_b64_tr_b16 a[212:213], v8 offset:32
    v_mfma_f32_16x16x32_bf16 v[92:95], a[124:127], v[40:43], v[92:95]
    v_exp_f32 v120, v120
    v_mfma_f32_16x16x32_bf16 v[96:99], a[96:99], v[44:47], v[80:83]
    ds_read_b64_tr_b16 a[214:215], v8 offset:544
    v_cvt_pk_bf16_f32 v140, v112, v113
    v_mfma_f32_16x16x32_bf16 v[96:99], a[100:103], v[48:51], v[96:99]
    v_exp_f32 v121, v121
    v_mfma_f32_16x16x32_bf16 v[96:99], a[104:107], v[52:55], v[96:99]
    ds_read_b64_tr_b16 a[216:217], v8 offset:64
    v_cvt_pk_bf16_f32 v141, v114, v115
    v_mfma_f32_16x16x32_bf16 v[96:99], a[108:111], v[56:59], v[96:99]
    v_exp_f32 v122, v122
    v_mfma_f32_16x16x32_bf16 v[100:103], a[112:115], v[44:47], v[80:83]
    ds_read_b64_tr_b16 a[218:219], v8 offset:576
    v_cvt_pk_bf16_f32 v142, v116, v117
    v_mfma_f32_16x16x32_bf16 v[100:103], a[116:119], v[48:51], v[100:103]
    v_exp_f32 v123, v123
    v_mfma_f32_16x16x32_bf16 v[100:103], a[120:123], v[52:55], v[100:103]
    ds_read_b64_tr_b16 a[220:221], v8 offset:96
    v_cvt_pk_bf16_f32 v143, v118, v119
    v_mfma_f32_16x16x32_bf16 v[100:103], a[124:127], v[56:59], v[100:103]
    v_exp_f32 v124, v124
    v_mfma_f32_16x16x32_bf16 v[104:107], a[96:99], v[60:63], v[84:87]
    ds_read_b64_tr_b16 a[222:223], v8 offset:608
    v_cvt_pk_bf16_f32 v144, v120, v121
    v_mfma_f32_16x16x32_bf16 v[104:107], a[100:103], v[64:67], v[104:107]
    v_exp_f32 v125, v125
    v_mfma_f32_16x16x32_bf16 v[104:107], a[104:107], v[68:71], v[104:107]
    ds_read_b128 a[128:131], v3 offset:16640
    v_cvt_pk_bf16_f32 v145, v122, v123
    v_mfma_f32_16x16x32_bf16 v[104:107], a[108:111], v[72:75], v[104:107]
    v_exp_f32 v126, v126
    v_mfma_f32_16x16x32_bf16 v[108:111], a[112:115], v[60:63], v[84:87]
    ds_read_b128 a[132:135], v3 offset:16704
    v_cvt_pk_bf16_f32 v146, v124, v125
    v_mfma_f32_16x16x32_bf16 v[108:111], a[116:119], v[64:67], v[108:111]
    v_exp_f32 v127, v127
    v_mfma_f32_16x16x32_bf16 v[108:111], a[120:123], v[68:71], v[108:111]
    ds_read_b128 a[136:139], v4 offset:16640
    v_cvt_pk_bf16_f32 v147, v126, v127
    v_mfma_f32_16x16x32_bf16 v[108:111], a[124:127], v[72:75], v[108:111]
    v_exp_f32 v88, v88
    v_mfma_f32_16x16x32_bf16 v[244:247], a[224:227], v[140:143], v[244:247]
    ds_read_b128 a[140:143], v4 offset:16704
    ds_read_b128 a[144:147], v3 offset:16896
    v_mfma_f32_16x16x32_bf16 v[148:151], a[192:195], v[140:143], v[148:151]
    s_waitcnt lgkmcnt(3)
    v_exp_f32 v89, v89
    v_mfma_f32_16x16x32_bf16 v[152:155], a[196:199], v[140:143], v[152:155]
    ds_read_b128 a[148:151], v3 offset:16960
    ds_read_b128 a[152:155], v4 offset:16896
    v_mfma_f32_16x16x32_bf16 v[156:159], a[200:203], v[140:143], v[156:159]
    v_exp_f32 v90, v90
    v_mfma_f32_16x16x32_bf16 v[160:163], a[204:207], v[140:143], v[160:163]
    ds_read_b128 a[156:159], v4 offset:16960
    v_cvt_pk_bf16_f32 v128, v88, v89
    v_mfma_f32_16x16x32_bf16 v[164:167], a[208:211], v[140:143], v[164:167]
    v_exp_f32 v91, v91
    v_mfma_f32_16x16x32_bf16 v[168:171], a[212:215], v[140:143], v[168:171]
    v_exp_f32 v92, v92
    v_mfma_f32_16x16x32_bf16 v[172:175], a[216:219], v[140:143], v[172:175]
    v_exp_f32 v93, v93
    v_mfma_f32_16x16x32_bf16 v[176:179], a[220:223], v[140:143], v[176:179]
    s_waitcnt vmcnt(4) lgkmcnt(0)
    s_barrier
    s_add_u32 m0, s89, 130048
    v_mfma_f32_16x16x32_bf16 v[248:251], a[224:227], v[144:147], v[248:251]
    buffer_load_dwordx4 v10, s[28:31], s82 offen nt lds
    v_mfma_f32_16x16x32_bf16 v[180:183], a[192:195], v[144:147], v[180:183]
    s_add_u32 m0, s89, 130848
    v_exp_f32 v94, v94
    v_mfma_f32_16x16x32_bf16 v[184:187], a[196:199], v[144:147], v[184:187]
    ds_read_b64_tr_b16 a[160:161], v5 offset:16896
    ds_read_b64_tr_b16 a[162:163], v5 offset:17408
    v_mfma_f32_16x16x32_bf16 v[188:191], a[200:203], v[144:147], v[188:191]
    v_exp_f32 v95, v95
    v_mfma_f32_16x16x32_bf16 v[192:195], a[204:207], v[144:147], v[192:195]
    buffer_load_dwordx4 v10, s[28:31], s82 offen offset:256 nt lds
    v_mfma_f32_16x16x32_bf16 v[196:199], a[208:211], v[144:147], v[196:199]
    s_add_u32 m0, s89, 131648
    v_exp_f32 v96, v96
    v_mfma_f32_16x16x32_bf16 v[200:203], a[212:215], v[144:147], v[200:203]
    buffer_load_dwordx4 v10, s[28:31], s82 offen offset:512 nt lds
    v_mfma_f32_16x16x32_bf16 v[204:207], a[216:219], v[144:147], v[204:207]
    s_add_u32 m0, s89, 132448
    v_exp_f32 v97, v97
    v_mfma_f32_16x16x32_bf16 v[208:211], a[220:223], v[144:147], v[208:211]
    ds_read_b64_tr_b16 a[164:165], v5 offset:16928
    ds_read_b64_tr_b16 a[166:167], v5 offset:17440
    v_mfma_f32_16x16x32_bf16 v[112:115], a[128:131], v[28:31], v[76:79]
    v_exp_f32 v98, v98
    v_mfma_f32_16x16x32_bf16 v[112:115], a[132:135], v[32:35], v[112:115]
    buffer_load_dwordx4 v10, s[28:31], s82 offen offset:768 nt lds
    v_mfma_f32_16x16x32_bf16 v[112:115], a[136:139], v[36:39], v[112:115]
    v_exp_f32 v99, v99
    v_mfma_f32_16x16x32_bf16 v[112:115], a[140:143], v[40:43], v[112:115]
    ds_read_b64_tr_b16 a[168:169], v5 offset:16960
    ds_read_b64_tr_b16 a[170:171], v5 offset:17472
    v_mfma_f32_16x16x32_bf16 v[116:119], a[144:147], v[28:31], v[76:79]
    v_exp_f32 v100, v100
    v_mfma_f32_16x16x32_bf16 v[116:119], a[148:151], v[32:35], v[116:119]
    ds_read_b64_tr_b16 a[172:173], v5 offset:16992
    ds_read_b64_tr_b16 a[174:175], v5 offset:17504
    v_mfma_f32_16x16x32_bf16 v[116:119], a[152:155], v[36:39], v[116:119]
    ds_read_b64_tr_b16 a[176:177], v6 offset:16896
    ds_read_b64_tr_b16 a[178:179], v6 offset:17408
    v_mfma_f32_16x16x32_bf16 v[116:119], a[156:159], v[40:43], v[116:119]
    v_cvt_pk_bf16_f32 v129, v90, v91
    v_cvt_pk_bf16_f32 v130, v92, v93
    v_mfma_f32_16x16x32_bf16 v[120:123], a[128:131], v[44:47], v[80:83]
    ds_read_b64_tr_b16 a[180:181], v6 offset:16928
    v_cvt_pk_bf16_f32 v131, v94, v95
    v_mfma_f32_16x16x32_bf16 v[120:123], a[132:135], v[48:51], v[120:123]
    ds_read_b64_tr_b16 a[182:183], v6 offset:17440
    ds_read_b64_tr_b16 a[184:185], v6 offset:16960
    v_mfma_f32_16x16x32_bf16 v[120:123], a[136:139], v[52:55], v[120:123]
    ds_read_b64_tr_b16 a[186:187], v6 offset:17472
    ds_read_b64_tr_b16 a[188:189], v6 offset:16992
    v_mfma_f32_16x16x32_bf16 v[120:123], a[140:143], v[56:59], v[120:123]
    ds_read_b64_tr_b16 a[190:191], v6 offset:17504
    v_cvt_pk_bf16_f32 v132, v96, v97
    v_mfma_f32_16x16x32_bf16 v[124:127], a[144:147], v[44:47], v[80:83]
    v_exp_f32 v101, v101
    v_mfma_f32_16x16x32_bf16 v[124:127], a[148:151], v[48:51], v[124:127]
    ds_read_b64_tr_b16 a[192:193], v7 offset:16896
    v_cvt_pk_bf16_f32 v133, v98, v99
    v_mfma_f32_16x16x32_bf16 v[124:127], a[152:155], v[52:55], v[124:127]
    v_exp_f32 v102, v102
    v_mfma_f32_16x16x32_bf16 v[124:127], a[156:159], v[56:59], v[124:127]
    s_waitcnt vmcnt(4) lgkmcnt(1)
    s_barrier
    s_add_u32 m0, s88, 113408
    v_mfma_f32_16x16x32_bf16 v[244:247], a[224:227], v[128:131], v[244:247]
    ds_read_b128 a[96:99], v1 offset:0
    v_cvt_pk_bf16_f32 v134, v100, v101
    v_mfma_f32_16x16x32_bf16 v[148:151], a[160:163], v[128:131], v[148:151]
    v_exp_f32 v103, v103
    v_mfma_f32_16x16x32_bf16 v[152:155], a[164:167], v[128:131], v[152:155]
    ds_read_b128 a[100:103], v1 offset:64
    v_cvt_pk_bf16_f32 v135, v102, v103
    v_mfma_f32_16x16x32_bf16 v[156:159], a[168:171], v[128:131], v[156:159]
    v_exp_f32 v104, v104
    v_mfma_f32_16x16x32_bf16 v[160:163], a[172:175], v[128:131], v[160:163]
    ds_read_b128 a[104:107], v2 offset:0
    ds_read_b128 a[108:111], v2 offset:64
    v_mfma_f32_16x16x32_bf16 v[164:167], a[176:179], v[128:131], v[164:167]
    v_exp_f32 v105, v105
    v_mfma_f32_16x16x32_bf16 v[168:171], a[180:183], v[128:131], v[168:171]
    ds_read_b128 a[112:115], v1 offset:256
    v_cvt_pk_bf16_f32 v136, v104, v105
    v_mfma_f32_16x16x32_bf16 v[172:175], a[184:187], v[128:131], v[172:175]
    v_exp_f32 v106, v106
    v_mfma_f32_16x16x32_bf16 v[176:179], a[188:191], v[128:131], v[176:179]
    ds_read_b128 a[116:119], v1 offset:320
    ds_read_b128 a[120:123], v2 offset:256
    v_mfma_f32_16x16x32_bf16 v[248:251], a[224:227], v[132:135], v[248:251]
    v_exp_f32 v107, v107
    v_mfma_f32_16x16x32_bf16 v[180:183], a[160:163], v[132:135], v[180:183]
    ds_read_b128 a[124:127], v2 offset:320
    v_cvt_pk_bf16_f32 v137, v106, v107
    v_mfma_f32_16x16x32_bf16 v[184:187], a[164:167], v[132:135], v[184:187]
    v_exp_f32 v108, v108
    v_mfma_f32_16x16x32_bf16 v[188:191], a[168:171], v[132:135], v[188:191]
    v_exp_f32 v109, v109
    v_mfma_f32_16x16x32_bf16 v[192:195], a[172:175], v[132:135], v[192:195]
    v_exp_f32 v110, v110
    v_mfma_f32_16x16x32_bf16 v[196:199], a[176:179], v[132:135], v[196:199]
    v_exp_f32 v111, v111
    v_mfma_f32_16x16x32_bf16 v[200:203], a[180:183], v[132:135], v[200:203]
    ds_read_b64_tr_b16 a[194:195], v7 offset:17408
    v_cvt_pk_bf16_f32 v138, v108, v109
    v_mfma_f32_16x16x32_bf16 v[204:207], a[184:187], v[132:135], v[204:207]
    ds_read_b64_tr_b16 a[196:197], v7 offset:16928
    v_cvt_pk_bf16_f32 v139, v110, v111
    v_mfma_f32_16x16x32_bf16 v[208:211], a[188:191], v[132:135], v[208:211]
    v_exp_f32 v112, v112
    v_mfma_f32_16x16x32_bf16 v[252:255], a[224:227], v[136:139], v[252:255]
    ds_read_b64_tr_b16 a[198:199], v7 offset:17440
    ds_read_b64_tr_b16 a[200:201], v7 offset:16960
    v_mfma_f32_16x16x32_bf16 v[212:215], a[160:163], v[136:139], v[212:215]
    v_exp_f32 v113, v113
    v_mfma_f32_16x16x32_bf16 v[216:219], a[164:167], v[136:139], v[216:219]
    ds_read_b64_tr_b16 a[202:203], v7 offset:17472
    ds_read_b64_tr_b16 a[204:205], v7 offset:16992
    v_mfma_f32_16x16x32_bf16 v[220:223], a[168:171], v[136:139], v[220:223]
    v_exp_f32 v114, v114
    v_mfma_f32_16x16x32_bf16 v[224:227], a[172:175], v[136:139], v[224:227]
    buffer_load_dwordx4 v9, s[24:27], s83 offen nt lds
    v_mfma_f32_16x16x32_bf16 v[228:231], a[176:179], v[136:139], v[228:231]
    s_add_u32 m0, s88, 115232
    v_exp_f32 v115, v115
    v_mfma_f32_16x16x32_bf16 v[232:235], a[180:183], v[136:139], v[232:235]
    ds_read_b64_tr_b16 a[206:207], v7 offset:17504
    ds_read_b64_tr_b16 a[208:209], v8 offset:16896
    v_mfma_f32_16x16x32_bf16 v[236:239], a[184:187], v[136:139], v[236:239]
    s_waitcnt lgkmcnt(2)
    v_exp_f32 v116, v116
    v_mfma_f32_16x16x32_bf16 v[240:243], a[188:191], v[136:139], v[240:243]
    buffer_load_dwordx4 v9, s[24:27], s83 offen offset:256 nt lds
    v_mfma_f32_16x16x32_bf16 v[88:91], a[96:99], v[28:31], v[76:79]
    s_add_u32 m0, s88, 117056
    v_exp_f32 v117, v117
    v_mfma_f32_16x16x32_bf16 v[88:91], a[100:103], v[32:35], v[88:91]
    ds_read_b64_tr_b16 a[210:211], v8 offset:17408
    ds_read_b64_tr_b16 a[212:213], v8 offset:16928
    v_mfma_f32_16x16x32_bf16 v[88:91], a[104:107], v[36:39], v[88:91]
    buffer_load_dwordx4 v9, s[24:27], s83 offen offset:512 nt lds
    v_mfma_f32_16x16x32_bf16 v[88:91], a[108:111], v[40:43], v[88:91]
    s_add_u32 m0, s88, 118880
    v_exp_f32 v118, v118
    v_mfma_f32_16x16x32_bf16 v[92:95], a[112:115], v[28:31], v[76:79]
    ds_read_b64_tr_b16 a[214:215], v8 offset:17440
    v_cvt_pk_bf16_f32 v140, v112, v113
    v_mfma_f32_16x16x32_bf16 v[92:95], a[116:119], v[32:35], v[92:95]
    v_exp_f32 v119, v119
    v_mfma_f32_16x16x32_bf16 v[92:95], a[120:123], v[36:39], v[92:95]
    buffer_load_dwordx4 v9, s[24:27], s83 offen offset:768 nt lds
    v_mfma_f32_16x16x32_bf16 v[92:95], a[124:127], v[40:43], v[92:95]
    v_exp_f32 v120, v120
    v_mfma_f32_16x16x32_bf16 v[96:99], a[96:99], v[44:47], v[80:83]
    ds_read_b64_tr_b16 a[216:217], v8 offset:16960
    v_cvt_pk_bf16_f32 v141, v114, v115
    v_mfma_f32_16x16x32_bf16 v[96:99], a[100:103], v[48:51], v[96:99]
    v_exp_f32 v121, v121
    v_mfma_f32_16x16x32_bf16 v[96:99], a[104:107], v[52:55], v[96:99]
    ds_read_b64_tr_b16 a[218:219], v8 offset:17472
    v_cvt_pk_bf16_f32 v142, v116, v117
    v_mfma_f32_16x16x32_bf16 v[96:99], a[108:111], v[56:59], v[96:99]
    v_exp_f32 v122, v122
    v_mfma_f32_16x16x32_bf16 v[100:103], a[112:115], v[44:47], v[80:83]
    ds_read_b64_tr_b16 a[220:221], v8 offset:16992
    v_cvt_pk_bf16_f32 v143, v118, v119
    v_mfma_f32_16x16x32_bf16 v[100:103], a[116:119], v[48:51], v[100:103]
    v_exp_f32 v123, v123
    v_mfma_f32_16x16x32_bf16 v[100:103], a[120:123], v[52:55], v[100:103]
    ds_read_b64_tr_b16 a[222:223], v8 offset:17504
    v_cvt_pk_bf16_f32 v144, v120, v121
    v_mfma_f32_16x16x32_bf16 v[100:103], a[124:127], v[56:59], v[100:103]
    v_exp_f32 v124, v124
    v_mfma_f32_16x16x32_bf16 v[104:107], a[96:99], v[60:63], v[84:87]
    ds_read_b128 a[128:131], v3 offset:0
    v_cvt_pk_bf16_f32 v145, v122, v123
    v_mfma_f32_16x16x32_bf16 v[104:107], a[100:103], v[64:67], v[104:107]
    v_exp_f32 v125, v125
    v_mfma_f32_16x16x32_bf16 v[104:107], a[104:107], v[68:71], v[104:107]
    ds_read_b128 a[132:135], v3 offset:64
    v_cvt_pk_bf16_f32 v146, v124, v125
    v_mfma_f32_16x16x32_bf16 v[104:107], a[108:111], v[72:75], v[104:107]
    v_exp_f32 v126, v126
    v_mfma_f32_16x16x32_bf16 v[108:111], a[112:115], v[60:63], v[84:87]
    ds_read_b128 a[136:139], v4 offset:0
    ds_read_b128 a[140:143], v4 offset:64
    v_mfma_f32_16x16x32_bf16 v[108:111], a[116:119], v[64:67], v[108:111]
    v_exp_f32 v127, v127
    v_mfma_f32_16x16x32_bf16 v[108:111], a[120:123], v[68:71], v[108:111]
    ds_read_b128 a[144:147], v3 offset:256
    v_cvt_pk_bf16_f32 v147, v126, v127
    v_mfma_f32_16x16x32_bf16 v[108:111], a[124:127], v[72:75], v[108:111]
    v_exp_f32 v88, v88
    v_mfma_f32_16x16x32_bf16 v[244:247], a[224:227], v[140:143], v[244:247]
    ds_read_b128 a[148:151], v3 offset:320
    ds_read_b128 a[152:155], v4 offset:256
    v_mfma_f32_16x16x32_bf16 v[148:151], a[192:195], v[140:143], v[148:151]
    v_exp_f32 v89, v89
    v_mfma_f32_16x16x32_bf16 v[152:155], a[196:199], v[140:143], v[152:155]
    ds_read_b128 a[156:159], v4 offset:320
    v_cvt_pk_bf16_f32 v128, v88, v89
    v_mfma_f32_16x16x32_bf16 v[156:159], a[200:203], v[140:143], v[156:159]
    s_waitcnt lgkmcnt(3)
    v_exp_f32 v90, v90
    v_mfma_f32_16x16x32_bf16 v[160:163], a[204:207], v[140:143], v[160:163]
    v_exp_f32 v91, v91
    v_mfma_f32_16x16x32_bf16 v[164:167], a[208:211], v[140:143], v[164:167]
    v_exp_f32 v92, v92
    v_mfma_f32_16x16x32_bf16 v[168:171], a[212:215], v[140:143], v[168:171]
    v_exp_f32 v93, v93
    v_mfma_f32_16x16x32_bf16 v[172:175], a[216:219], v[140:143], v[172:175]
    v_exp_f32 v94, v94
    v_mfma_f32_16x16x32_bf16 v[176:179], a[220:223], v[140:143], v[176:179]
    s_waitcnt vmcnt(4) lgkmcnt(0)
    s_barrier
    s_add_u32 m0, s89, 146944
    v_mfma_f32_16x16x32_bf16 v[248:251], a[224:227], v[144:147], v[248:251]
    ds_read_b64_tr_b16 a[160:161], v5 offset:0
    ds_read_b64_tr_b16 a[162:163], v5 offset:512
    v_mfma_f32_16x16x32_bf16 v[180:183], a[192:195], v[144:147], v[180:183]
    v_exp_f32 v95, v95
    v_mfma_f32_16x16x32_bf16 v[184:187], a[196:199], v[144:147], v[184:187]
    ds_read_b64_tr_b16 a[164:165], v5 offset:32
    ds_read_b64_tr_b16 a[166:167], v5 offset:544
    v_mfma_f32_16x16x32_bf16 v[188:191], a[200:203], v[144:147], v[188:191]
    v_exp_f32 v96, v96
    v_mfma_f32_16x16x32_bf16 v[192:195], a[204:207], v[144:147], v[192:195]
    ds_read_b64_tr_b16 a[168:169], v5 offset:64
    ds_read_b64_tr_b16 a[170:171], v5 offset:576
    v_mfma_f32_16x16x32_bf16 v[196:199], a[208:211], v[144:147], v[196:199]
    v_exp_f32 v97, v97
    v_mfma_f32_16x16x32_bf16 v[200:203], a[212:215], v[144:147], v[200:203]
    buffer_load_dwordx4 v10, s[28:31], s83 offen nt lds
    v_mfma_f32_16x16x32_bf16 v[204:207], a[216:219], v[144:147], v[204:207]
    s_add_u32 m0, s89, 147744
    v_exp_f32 v98, v98
    v_mfma_f32_16x16x32_bf16 v[208:211], a[220:223], v[144:147], v[208:211]
    ds_read_b64_tr_b16 a[172:173], v5 offset:96
    ds_read_b64_tr_b16 a[174:175], v5 offset:608
    v_mfma_f32_16x16x32_bf16 v[112:115], a[128:131], v[28:31], v[76:79]
    v_exp_f32 v99, v99
    v_mfma_f32_16x16x32_bf16 v[112:115], a[132:135], v[32:35], v[112:115]
    buffer_load_dwordx4 v10, s[28:31], s83 offen offset:256 nt lds
    v_mfma_f32_16x16x32_bf16 v[112:115], a[136:139], v[36:39], v[112:115]
    s_add_u32 m0, s89, 148544
    v_exp_f32 v100, v100
    v_mfma_f32_16x16x32_bf16 v[112:115], a[140:143], v[40:43], v[112:115]
    ds_read_b64_tr_b16 a[176:177], v6 offset:0
    ds_read_b64_tr_b16 a[178:179], v6 offset:512
    v_mfma_f32_16x16x32_bf16 v[116:119], a[144:147], v[28:31], v[76:79]
    v_exp_f32 v101, v101
    v_mfma_f32_16x16x32_bf16 v[116:119], a[148:151], v[32:35], v[116:119]
    buffer_load_dwordx4 v10, s[28:31], s83 offen offset:512 nt lds
    v_mfma_f32_16x16x32_bf16 v[116:119], a[152:155], v[36:39], v[116:119]
    s_add_u32 m0, s89, 149344
    v_cvt_pk_bf16_f32 v129, v90, v91
    v_cvt_pk_bf16_f32 v130, v92, v93
    v_mfma_f32_16x16x32_bf16 v[116:119], a[156:159], v[40:43], v[116:119]
    ds_read_b64_tr_b16 a[180:181], v6 offset:32
    v_cvt_pk_bf16_f32 v131, v94, v95
    v_mfma_f32_16x16x32_bf16 v[120:123], a[128:131], v[44:47], v[80:83]
    v_exp_f32 v102, v102
    v_mfma_f32_16x16x32_bf16 v[120:123], a[132:135], v[48:51], v[120:123]
    buffer_load_dwordx4 v10, s[28:31], s83 offen offset:768 nt lds
    ds_read_b64_tr_b16 a[182:183], v6 offset:544
    v_mfma_f32_16x16x32_bf16 v[120:123], a[136:139], v[52:55], v[120:123]
    ds_read_b64_tr_b16 a[184:185], v6 offset:64
    ds_read_b64_tr_b16 a[186:187], v6 offset:576
    v_mfma_f32_16x16x32_bf16 v[120:123], a[140:143], v[56:59], v[120:123]
    ds_read_b64_tr_b16 a[188:189], v6 offset:96
    ds_read_b64_tr_b16 a[190:191], v6 offset:608
    v_mfma_f32_16x16x32_bf16 v[124:127], a[144:147], v[44:47], v[80:83]
    v_exp_f32 v103, v103
    v_mfma_f32_16x16x32_bf16 v[124:127], a[148:151], v[48:51], v[124:127]
    ds_read_b64_tr_b16 a[192:193], v7 offset:0
    v_cvt_pk_bf16_f32 v132, v96, v97
    v_mfma_f32_16x16x32_bf16 v[124:127], a[152:155], v[52:55], v[124:127]
    v_exp_f32 v104, v104
    v_mfma_f32_16x16x32_bf16 v[124:127], a[156:159], v[56:59], v[124:127]
    s_waitcnt vmcnt(4) lgkmcnt(1)
    s_barrier
    s_add_u32 m0, s88, 96768
    v_mfma_f32_16x16x32_bf16 v[244:247], a[224:227], v[128:131], v[244:247]
    ds_read_b128 a[96:99], v1 offset:16640
    v_cvt_pk_bf16_f32 v133, v98, v99
    v_mfma_f32_16x16x32_bf16 v[148:151], a[160:163], v[128:131], v[148:151]
    v_exp_f32 v105, v105
    v_mfma_f32_16x16x32_bf16 v[152:155], a[164:167], v[128:131], v[152:155]
    ds_read_b128 a[100:103], v1 offset:16704
    v_cvt_pk_bf16_f32 v134, v100, v101
    v_mfma_f32_16x16x32_bf16 v[156:159], a[168:171], v[128:131], v[156:159]
    v_exp_f32 v106, v106
    v_mfma_f32_16x16x32_bf16 v[160:163], a[172:175], v[128:131], v[160:163]
    ds_read_b128 a[104:107], v2 offset:16640
    v_cvt_pk_bf16_f32 v135, v102, v103
    v_mfma_f32_16x16x32_bf16 v[164:167], a[176:179], v[128:131], v[164:167]
    v_exp_f32 v107, v107
    v_mfma_f32_16x16x32_bf16 v[168:171], a[180:183], v[128:131], v[168:171]
    ds_read_b128 a[108:111], v2 offset:16704
    v_cvt_pk_bf16_f32 v136, v104, v105
    v_mfma_f32_16x16x32_bf16 v[172:175], a[184:187], v[128:131], v[172:175]
    v_exp_f32 v108, v108
    v_mfma_f32_16x16x32_bf16 v[176:179], a[188:191], v[128:131], v[176:179]
    ds_read_b128 a[112:115], v1 offset:16896
    v_cvt_pk_bf16_f32 v137, v106, v107
    v_mfma_f32_16x16x32_bf16 v[248:251], a[224:227], v[132:135], v[248:251]
    v_exp_f32 v109, v109
    v_mfma_f32_16x16x32_bf16 v[180:183], a[160:163], v[132:135], v[180:183]
    ds_read_b128 a[116:119], v1 offset:16960
    v_cvt_pk_bf16_f32 v138, v108, v109
    v_mfma_f32_16x16x32_bf16 v[184:187], a[164:167], v[132:135], v[184:187]
    v_exp_f32 v110, v110
    v_mfma_f32_16x16x32_bf16 v[188:191], a[168:171], v[132:135], v[188:191]
    ds_read_b128 a[120:123], v2 offset:16896
    ds_read_b128 a[124:127], v2 offset:16960
    v_mfma_f32_16x16x32_bf16 v[192:195], a[172:175], v[132:135], v[192:195]
    v_exp_f32 v111, v111
    v_mfma_f32_16x16x32_bf16 v[196:199], a[176:179], v[132:135], v[196:199]
    ds_read_b64_tr_b16 a[194:195], v7 offset:512
    v_cvt_pk_bf16_f32 v139, v110, v111
    v_mfma_f32_16x16x32_bf16 v[200:203], a[180:183], v[132:135], v[200:203]
    v_exp_f32 v112, v112
    v_mfma_f32_16x16x32_bf16 v[204:207], a[184:187], v[132:135], v[204:207]
    ds_read_b64_tr_b16 a[196:197], v7 offset:32
    ds_read_b64_tr_b16 a[198:199], v7 offset:544
    v_mfma_f32_16x16x32_bf16 v[208:211], a[188:191], v[132:135], v[208:211]
    v_exp_f32 v113, v113
    v_mfma_f32_16x16x32_bf16 v[252:255], a[224:227], v[136:139], v[252:255]
    ds_read_b64_tr_b16 a[200:201], v7 offset:64
    ds_read_b64_tr_b16 a[202:203], v7 offset:576
    v_mfma_f32_16x16x32_bf16 v[212:215], a[160:163], v[136:139], v[212:215]
    v_exp_f32 v114, v114
    v_mfma_f32_16x16x32_bf16 v[216:219], a[164:167], v[136:139], v[216:219]
    ds_read_b64_tr_b16 a[204:205], v7 offset:96
    ds_read_b64_tr_b16 a[206:207], v7 offset:608
    v_mfma_f32_16x16x32_bf16 v[220:223], a[168:171], v[136:139], v[220:223]
    v_exp_f32 v115, v115
    v_mfma_f32_16x16x32_bf16 v[224:227], a[172:175], v[136:139], v[224:227]
    buffer_load_dwordx4 v9, s[24:27], s84 offen nt lds
    v_mfma_f32_16x16x32_bf16 v[228:231], a[176:179], v[136:139], v[228:231]
    s_add_u32 m0, s88, 98592
    v_exp_f32 v116, v116
    v_mfma_f32_16x16x32_bf16 v[232:235], a[180:183], v[136:139], v[232:235]
    ds_read_b64_tr_b16 a[208:209], v8 offset:0
    ds_read_b64_tr_b16 a[210:211], v8 offset:512
    v_mfma_f32_16x16x32_bf16 v[236:239], a[184:187], v[136:139], v[236:239]
    s_waitcnt lgkmcnt(2)
    v_exp_f32 v117, v117
    v_mfma_f32_16x16x32_bf16 v[240:243], a[188:191], v[136:139], v[240:243]
    buffer_load_dwordx4 v9, s[24:27], s84 offen offset:256 nt lds
    v_mfma_f32_16x16x32_bf16 v[88:91], a[96:99], v[28:31], v[76:79]
    s_add_u32 m0, s88, 100416
    v_exp_f32 v118, v118
    v_mfma_f32_16x16x32_bf16 v[88:91], a[100:103], v[32:35], v[88:91]
    ds_read_b64_tr_b16 a[212:213], v8 offset:32
    ds_read_b64_tr_b16 a[214:215], v8 offset:544
    v_mfma_f32_16x16x32_bf16 v[88:91], a[104:107], v[36:39], v[88:91]
    buffer_load_dwordx4 v9, s[24:27], s84 offen offset:512 nt lds
    v_mfma_f32_16x16x32_bf16 v[88:91], a[108:111], v[40:43], v[88:91]
    s_add_u32 m0, s88, 102240
    v_exp_f32 v119, v119
    v_mfma_f32_16x16x32_bf16 v[92:95], a[112:115], v[28:31], v[76:79]
    ds_read_b64_tr_b16 a[216:217], v8 offset:64
    v_cvt_pk_bf16_f32 v140, v112, v113
    v_mfma_f32_16x16x32_bf16 v[92:95], a[116:119], v[32:35], v[92:95]
    v_exp_f32 v120, v120
    v_mfma_f32_16x16x32_bf16 v[92:95], a[120:123], v[36:39], v[92:95]
    buffer_load_dwordx4 v9, s[24:27], s84 offen offset:768 nt lds
    v_mfma_f32_16x16x32_bf16 v[92:95], a[124:127], v[40:43], v[92:95]
    v_exp_f32 v121, v121
    v_mfma_f32_16x16x32_bf16 v[96:99], a[96:99], v[44:47], v[80:83]
    ds_read_b64_tr_b16 a[218:219], v8 offset:576
    v_cvt_pk_bf16_f32 v141, v114, v115
    v_mfma_f32_16x16x32_bf16 v[96:99], a[100:103], v[48:51], v[96:99]
    v_exp_f32 v122, v122
    v_mfma_f32_16x16x32_bf16 v[96:99], a[104:107], v[52:55], v[96:99]
    ds_read_b64_tr_b16 a[220:221], v8 offset:96
    v_cvt_pk_bf16_f32 v142, v116, v117
    v_mfma_f32_16x16x32_bf16 v[96:99], a[108:111], v[56:59], v[96:99]
    v_exp_f32 v123, v123
    v_mfma_f32_16x16x32_bf16 v[100:103], a[112:115], v[44:47], v[80:83]
    ds_read_b64_tr_b16 a[222:223], v8 offset:608
    v_cvt_pk_bf16_f32 v143, v118, v119
    v_mfma_f32_16x16x32_bf16 v[100:103], a[116:119], v[48:51], v[100:103]
    v_exp_f32 v124, v124
    v_mfma_f32_16x16x32_bf16 v[100:103], a[120:123], v[52:55], v[100:103]
    ds_read_b128 a[128:131], v3 offset:16640
    v_cvt_pk_bf16_f32 v144, v120, v121
    v_mfma_f32_16x16x32_bf16 v[100:103], a[124:127], v[56:59], v[100:103]
    v_exp_f32 v125, v125
    v_mfma_f32_16x16x32_bf16 v[104:107], a[96:99], v[60:63], v[84:87]
    ds_read_b128 a[132:135], v3 offset:16704
    v_cvt_pk_bf16_f32 v145, v122, v123
    v_mfma_f32_16x16x32_bf16 v[104:107], a[100:103], v[64:67], v[104:107]
    v_exp_f32 v126, v126
    v_mfma_f32_16x16x32_bf16 v[104:107], a[104:107], v[68:71], v[104:107]
    ds_read_b128 a[136:139], v4 offset:16640
    v_cvt_pk_bf16_f32 v146, v124, v125
    v_mfma_f32_16x16x32_bf16 v[104:107], a[108:111], v[72:75], v[104:107]
    v_exp_f32 v127, v127
    v_mfma_f32_16x16x32_bf16 v[108:111], a[112:115], v[60:63], v[84:87]
    ds_read_b128 a[140:143], v4 offset:16704
    v_cvt_pk_bf16_f32 v147, v126, v127
    v_mfma_f32_16x16x32_bf16 v[108:111], a[116:119], v[64:67], v[108:111]
    v_exp_f32 v88, v88
    v_mfma_f32_16x16x32_bf16 v[108:111], a[120:123], v[68:71], v[108:111]
    ds_read_b128 a[144:147], v3 offset:16896
    ds_read_b128 a[148:151], v3 offset:16960
    v_mfma_f32_16x16x32_bf16 v[108:111], a[124:127], v[72:75], v[108:111]
    v_exp_f32 v89, v89
    v_mfma_f32_16x16x32_bf16 v[244:247], a[224:227], v[140:143], v[244:247]
    ds_read_b128 a[152:155], v4 offset:16896
    ds_read_b128 a[156:159], v4 offset:16960
    v_mfma_f32_16x16x32_bf16 v[148:151], a[192:195], v[140:143], v[148:151]
    v_exp_f32 v90, v90
    v_mfma_f32_16x16x32_bf16 v[152:155], a[196:199], v[140:143], v[152:155]
    v_exp_f32 v91, v91
    v_mfma_f32_16x16x32_bf16 v[156:159], a[200:203], v[140:143], v[156:159]
    v_exp_f32 v92, v92
    v_mfma_f32_16x16x32_bf16 v[160:163], a[204:207], v[140:143], v[160:163]
    s_waitcnt lgkmcnt(0)
    v_exp_f32 v93, v93
    v_mfma_f32_16x16x32_bf16 v[164:167], a[208:211], v[140:143], v[164:167]
    v_exp_f32 v94, v94
    v_mfma_f32_16x16x32_bf16 v[168:171], a[212:215], v[140:143], v[168:171]
    v_exp_f32 v95, v95
    v_mfma_f32_16x16x32_bf16 v[172:175], a[216:219], v[140:143], v[172:175]
    v_cvt_pk_bf16_f32 v128, v88, v89
    v_cvt_pk_bf16_f32 v129, v90, v91
    v_mfma_f32_16x16x32_bf16 v[176:179], a[220:223], v[140:143], v[176:179]
    s_waitcnt vmcnt(4)
    s_barrier
    s_add_u32 m0, s89, 130048
    v_mfma_f32_16x16x32_bf16 v[248:251], a[224:227], v[144:147], v[248:251]
    ds_read_b64_tr_b16 a[160:161], v5 offset:16896
    ds_read_b64_tr_b16 a[162:163], v5 offset:17408
    v_mfma_f32_16x16x32_bf16 v[180:183], a[192:195], v[144:147], v[180:183]
    v_exp_f32 v96, v96
    v_mfma_f32_16x16x32_bf16 v[184:187], a[196:199], v[144:147], v[184:187]
    ds_read_b64_tr_b16 a[164:165], v5 offset:16928
    ds_read_b64_tr_b16 a[166:167], v5 offset:17440
    v_mfma_f32_16x16x32_bf16 v[188:191], a[200:203], v[144:147], v[188:191]
    v_exp_f32 v97, v97
    v_mfma_f32_16x16x32_bf16 v[192:195], a[204:207], v[144:147], v[192:195]
    ds_read_b64_tr_b16 a[168:169], v5 offset:16960
    ds_read_b64_tr_b16 a[170:171], v5 offset:17472
    v_mfma_f32_16x16x32_bf16 v[196:199], a[208:211], v[144:147], v[196:199]
    v_exp_f32 v98, v98
    v_mfma_f32_16x16x32_bf16 v[200:203], a[212:215], v[144:147], v[200:203]
    buffer_load_dwordx4 v10, s[28:31], s84 offen nt lds
    v_mfma_f32_16x16x32_bf16 v[204:207], a[216:219], v[144:147], v[204:207]
    s_add_u32 m0, s89, 130848
    v_exp_f32 v99, v99
    v_mfma_f32_16x16x32_bf16 v[208:211], a[220:223], v[144:147], v[208:211]
    ds_read_b64_tr_b16 a[172:173], v5 offset:16992
    ds_read_b64_tr_b16 a[174:175], v5 offset:17504
    v_mfma_f32_16x16x32_bf16 v[112:115], a[128:131], v[28:31], v[76:79]
    v_exp_f32 v100, v100
    v_mfma_f32_16x16x32_bf16 v[112:115], a[132:135], v[32:35], v[112:115]
    buffer_load_dwordx4 v10, s[28:31], s84 offen offset:256 nt lds
    v_mfma_f32_16x16x32_bf16 v[112:115], a[136:139], v[36:39], v[112:115]
    s_add_u32 m0, s89, 131648
    v_exp_f32 v101, v101
    v_mfma_f32_16x16x32_bf16 v[112:115], a[140:143], v[40:43], v[112:115]
    ds_read_b64_tr_b16 a[176:177], v6 offset:16896
    ds_read_b64_tr_b16 a[178:179], v6 offset:17408
    v_mfma_f32_16x16x32_bf16 v[116:119], a[144:147], v[28:31], v[76:79]
    v_exp_f32 v102, v102
    v_mfma_f32_16x16x32_bf16 v[116:119], a[148:151], v[32:35], v[116:119]
    buffer_load_dwordx4 v10, s[28:31], s84 offen offset:512 nt lds
    v_mfma_f32_16x16x32_bf16 v[116:119], a[152:155], v[36:39], v[116:119]
    s_add_u32 m0, s89, 132448
    v_exp_f32 v103, v103
    v_mfma_f32_16x16x32_bf16 v[116:119], a[156:159], v[40:43], v[116:119]
    ds_read_b64_tr_b16 a[180:181], v6 offset:16928
    v_cvt_pk_bf16_f32 v130, v92, v93
    v_mfma_f32_16x16x32_bf16 v[120:123], a[128:131], v[44:47], v[80:83]
    ds_read_b64_tr_b16 a[182:183], v6 offset:17440
    v_cvt_pk_bf16_f32 v131, v94, v95
    v_mfma_f32_16x16x32_bf16 v[120:123], a[132:135], v[48:51], v[120:123]
    buffer_load_dwordx4 v10, s[28:31], s84 offen offset:768 nt lds
    v_mfma_f32_16x16x32_bf16 v[120:123], a[136:139], v[52:55], v[120:123]
    ds_read_b64_tr_b16 a[184:185], v6 offset:16960
    ds_read_b64_tr_b16 a[186:187], v6 offset:17472
    v_mfma_f32_16x16x32_bf16 v[120:123], a[140:143], v[56:59], v[120:123]
    ds_read_b64_tr_b16 a[188:189], v6 offset:16992
    ds_read_b64_tr_b16 a[190:191], v6 offset:17504
    v_mfma_f32_16x16x32_bf16 v[124:127], a[144:147], v[44:47], v[80:83]
    v_exp_f32 v104, v104
    v_mfma_f32_16x16x32_bf16 v[124:127], a[148:151], v[48:51], v[124:127]
    ds_read_b64_tr_b16 a[192:193], v7 offset:16896
    v_cvt_pk_bf16_f32 v132, v96, v97
    v_mfma_f32_16x16x32_bf16 v[124:127], a[152:155], v[52:55], v[124:127]
    v_exp_f32 v105, v105
    v_mfma_f32_16x16x32_bf16 v[124:127], a[156:159], v[56:59], v[124:127]
    s_waitcnt vmcnt(4) lgkmcnt(1)
    s_barrier
    s_add_u32 m0, s88, 113408
    v_mfma_f32_16x16x32_bf16 v[244:247], a[224:227], v[128:131], v[244:247]
    ds_read_b128 a[96:99], v1 offset:0
    v_cvt_pk_bf16_f32 v133, v98, v99
    v_mfma_f32_16x16x32_bf16 v[148:151], a[160:163], v[128:131], v[148:151]
    v_exp_f32 v106, v106
    v_mfma_f32_16x16x32_bf16 v[152:155], a[164:167], v[128:131], v[152:155]
    ds_read_b128 a[100:103], v1 offset:64
    v_cvt_pk_bf16_f32 v134, v100, v101
    v_mfma_f32_16x16x32_bf16 v[156:159], a[168:171], v[128:131], v[156:159]
    v_exp_f32 v107, v107
    v_mfma_f32_16x16x32_bf16 v[160:163], a[172:175], v[128:131], v[160:163]
    ds_read_b128 a[104:107], v2 offset:0
    v_cvt_pk_bf16_f32 v135, v102, v103
    v_mfma_f32_16x16x32_bf16 v[164:167], a[176:179], v[128:131], v[164:167]
    v_exp_f32 v108, v108
    v_mfma_f32_16x16x32_bf16 v[168:171], a[180:183], v[128:131], v[168:171]
    ds_read_b128 a[108:111], v2 offset:64
    v_cvt_pk_bf16_f32 v136, v104, v105
    v_mfma_f32_16x16x32_bf16 v[172:175], a[184:187], v[128:131], v[172:175]
    v_exp_f32 v109, v109
    v_mfma_f32_16x16x32_bf16 v[176:179], a[188:191], v[128:131], v[176:179]
    ds_read_b128 a[112:115], v1 offset:256
    v_cvt_pk_bf16_f32 v137, v106, v107
    v_mfma_f32_16x16x32_bf16 v[248:251], a[224:227], v[132:135], v[248:251]
    v_exp_f32 v110, v110
    v_mfma_f32_16x16x32_bf16 v[180:183], a[160:163], v[132:135], v[180:183]
    ds_read_b128 a[116:119], v1 offset:320
    v_cvt_pk_bf16_f32 v138, v108, v109
    v_mfma_f32_16x16x32_bf16 v[184:187], a[164:167], v[132:135], v[184:187]
    v_exp_f32 v111, v111
    v_mfma_f32_16x16x32_bf16 v[188:191], a[168:171], v[132:135], v[188:191]
    ds_read_b128 a[120:123], v2 offset:256
    v_cvt_pk_bf16_f32 v139, v110, v111
    v_mfma_f32_16x16x32_bf16 v[192:195], a[172:175], v[132:135], v[192:195]
    v_exp_f32 v112, v112
    v_mfma_f32_16x16x32_bf16 v[196:199], a[176:179], v[132:135], v[196:199]
    ds_read_b64_tr_b16 a[194:195], v7 offset:17408
    ds_read_b128 a[124:127], v2 offset:320
    v_mfma_f32_16x16x32_bf16 v[200:203], a[180:183], v[132:135], v[200:203]
    v_exp_f32 v113, v113
    v_mfma_f32_16x16x32_bf16 v[204:207], a[184:187], v[132:135], v[204:207]
    ds_read_b64_tr_b16 a[196:197], v7 offset:16928
    ds_read_b64_tr_b16 a[198:199], v7 offset:17440
    v_mfma_f32_16x16x32_bf16 v[208:211], a[188:191], v[132:135], v[208:211]
    v_exp_f32 v114, v114
    v_mfma_f32_16x16x32_bf16 v[252:255], a[224:227], v[136:139], v[252:255]
    ds_read_b64_tr_b16 a[200:201], v7 offset:16960
    ds_read_b64_tr_b16 a[202:203], v7 offset:17472
    v_mfma_f32_16x16x32_bf16 v[212:215], a[160:163], v[136:139], v[212:215]
    v_exp_f32 v115, v115
    v_mfma_f32_16x16x32_bf16 v[216:219], a[164:167], v[136:139], v[216:219]
    ds_read_b64_tr_b16 a[204:205], v7 offset:16992
    ds_read_b64_tr_b16 a[206:207], v7 offset:17504
    v_mfma_f32_16x16x32_bf16 v[220:223], a[168:171], v[136:139], v[220:223]
    v_exp_f32 v116, v116
    v_mfma_f32_16x16x32_bf16 v[224:227], a[172:175], v[136:139], v[224:227]
    buffer_load_dwordx4 v9, s[24:27], s85 offen nt lds
    v_mfma_f32_16x16x32_bf16 v[228:231], a[176:179], v[136:139], v[228:231]
    s_add_u32 m0, s88, 115232
    v_exp_f32 v117, v117
    v_mfma_f32_16x16x32_bf16 v[232:235], a[180:183], v[136:139], v[232:235]
    ds_read_b64_tr_b16 a[208:209], v8 offset:16896
    ds_read_b64_tr_b16 a[210:211], v8 offset:17408
    v_mfma_f32_16x16x32_bf16 v[236:239], a[184:187], v[136:139], v[236:239]
    s_waitcnt lgkmcnt(2)
    v_exp_f32 v118, v118
    v_mfma_f32_16x16x32_bf16 v[240:243], a[188:191], v[136:139], v[240:243]
    buffer_load_dwordx4 v9, s[24:27], s85 offen offset:256 nt lds
    v_mfma_f32_16x16x32_bf16 v[88:91], a[96:99], v[28:31], v[76:79]
    s_add_u32 m0, s88, 117056
    v_exp_f32 v119, v119
    v_mfma_f32_16x16x32_bf16 v[88:91], a[100:103], v[32:35], v[88:91]
    ds_read_b64_tr_b16 a[212:213], v8 offset:16928
    ds_read_b64_tr_b16 a[214:215], v8 offset:17440
    v_mfma_f32_16x16x32_bf16 v[88:91], a[104:107], v[36:39], v[88:91]
    v_exp_f32 v120, v120
    v_mfma_f32_16x16x32_bf16 v[88:91], a[108:111], v[40:43], v[88:91]
    buffer_load_dwordx4 v9, s[24:27], s85 offen offset:512 nt lds
    v_mfma_f32_16x16x32_bf16 v[92:95], a[112:115], v[28:31], v[76:79]
    s_add_u32 m0, s88, 118880
    v_exp_f32 v121, v121
    v_mfma_f32_16x16x32_bf16 v[92:95], a[116:119], v[32:35], v[92:95]
    ds_read_b64_tr_b16 a[216:217], v8 offset:16960
    v_cvt_pk_bf16_f32 v140, v112, v113
    v_mfma_f32_16x16x32_bf16 v[92:95], a[120:123], v[36:39], v[92:95]
    v_exp_f32 v122, v122
    v_mfma_f32_16x16x32_bf16 v[92:95], a[124:127], v[40:43], v[92:95]
    buffer_load_dwordx4 v9, s[24:27], s85 offen offset:768 nt lds
    v_mfma_f32_16x16x32_bf16 v[96:99], a[96:99], v[44:47], v[80:83]
    v_exp_f32 v123, v123
    v_mfma_f32_16x16x32_bf16 v[96:99], a[100:103], v[48:51], v[96:99]
    ds_read_b64_tr_b16 a[218:219], v8 offset:17472
    v_cvt_pk_bf16_f32 v141, v114, v115
    v_mfma_f32_16x16x32_bf16 v[96:99], a[104:107], v[52:55], v[96:99]
    v_exp_f32 v124, v124
    v_mfma_f32_16x16x32_bf16 v[96:99], a[108:111], v[56:59], v[96:99]
    ds_read_b64_tr_b16 a[220:221], v8 offset:16992
    v_cvt_pk_bf16_f32 v142, v116, v117
    v_mfma_f32_16x16x32_bf16 v[100:103], a[112:115], v[44:47], v[80:83]
    v_exp_f32 v125, v125
    v_mfma_f32_16x16x32_bf16 v[100:103], a[116:119], v[48:51], v[100:103]
    ds_read_b64_tr_b16 a[222:223], v8 offset:17504
    v_cvt_pk_bf16_f32 v143, v118, v119
    v_mfma_f32_16x16x32_bf16 v[100:103], a[120:123], v[52:55], v[100:103]
    v_exp_f32 v126, v126
    v_mfma_f32_16x16x32_bf16 v[100:103], a[124:127], v[56:59], v[100:103]
    ds_read_b128 a[128:131], v3 offset:0
    v_cvt_pk_bf16_f32 v144, v120, v121
    v_mfma_f32_16x16x32_bf16 v[104:107], a[96:99], v[60:63], v[84:87]
    v_exp_f32 v127, v127
    v_mfma_f32_16x16x32_bf16 v[104:107], a[100:103], v[64:67], v[104:107]
    ds_read_b128 a[132:135], v3 offset:64
    v_cvt_pk_bf16_f32 v145, v122, v123
    v_mfma_f32_16x16x32_bf16 v[104:107], a[104:107], v[68:71], v[104:107]
    v_exp_f32 v88, v88
    v_mfma_f32_16x16x32_bf16 v[104:107], a[108:111], v[72:75], v[104:107]
    ds_read_b128 a[136:139], v4 offset:0
    v_cvt_pk_bf16_f32 v146, v124, v125
    v_mfma_f32_16x16x32_bf16 v[108:111], a[112:115], v[60:63], v[84:87]
    v_exp_f32 v89, v89
    v_mfma_f32_16x16x32_bf16 v[108:111], a[116:119], v[64:67], v[108:111]
    ds_read_b128 a[140:143], v4 offset:64
    v_cvt_pk_bf16_f32 v147, v126, v127
    v_mfma_f32_16x16x32_bf16 v[108:111], a[120:123], v[68:71], v[108:111]
    v_exp_f32 v90, v90
    v_mfma_f32_16x16x32_bf16 v[108:111], a[124:127], v[72:75], v[108:111]
    ds_read_b128 a[144:147], v3 offset:256
    ds_read_b128 a[148:151], v3 offset:320
    v_mfma_f32_16x16x32_bf16 v[244:247], a[224:227], v[140:143], v[244:247]
    v_exp_f32 v91, v91
    v_mfma_f32_16x16x32_bf16 v[148:151], a[192:195], v[140:143], v[148:151]
    ds_read_b128 a[152:155], v4 offset:256
    ds_read_b128 a[156:159], v4 offset:320
    v_mfma_f32_16x16x32_bf16 v[152:155], a[196:199], v[140:143], v[152:155]
    v_exp_f32 v92, v92
    v_mfma_f32_16x16x32_bf16 v[156:159], a[200:203], v[140:143], v[156:159]
    v_exp_f32 v93, v93
    v_mfma_f32_16x16x32_bf16 v[160:163], a[204:207], v[140:143], v[160:163]
    s_waitcnt lgkmcnt(2)
    v_exp_f32 v94, v94
    v_mfma_f32_16x16x32_bf16 v[164:167], a[208:211], v[140:143], v[164:167]
    v_exp_f32 v95, v95
    v_mfma_f32_16x16x32_bf16 v[168:171], a[212:215], v[140:143], v[168:171]
    v_cvt_pk_bf16_f32 v128, v88, v89
    v_cvt_pk_bf16_f32 v129, v90, v91
    v_mfma_f32_16x16x32_bf16 v[172:175], a[216:219], v[140:143], v[172:175]
    v_cvt_pk_bf16_f32 v130, v92, v93
    v_cvt_pk_bf16_f32 v131, v94, v95
    v_mfma_f32_16x16x32_bf16 v[176:179], a[220:223], v[140:143], v[176:179]
    s_waitcnt vmcnt(4) lgkmcnt(0)
    s_barrier
    s_add_u32 m0, s89, 146944
    v_mfma_f32_16x16x32_bf16 v[248:251], a[224:227], v[144:147], v[248:251]
    ds_read_b64_tr_b16 a[160:161], v5 offset:0
    ds_read_b64_tr_b16 a[162:163], v5 offset:512
    v_mfma_f32_16x16x32_bf16 v[180:183], a[192:195], v[144:147], v[180:183]
    v_exp_f32 v96, v96
    v_mfma_f32_16x16x32_bf16 v[184:187], a[196:199], v[144:147], v[184:187]
    ds_read_b64_tr_b16 a[164:165], v5 offset:32
    ds_read_b64_tr_b16 a[166:167], v5 offset:544
    v_mfma_f32_16x16x32_bf16 v[188:191], a[200:203], v[144:147], v[188:191]
    v_exp_f32 v97, v97
    v_mfma_f32_16x16x32_bf16 v[192:195], a[204:207], v[144:147], v[192:195]
    ds_read_b64_tr_b16 a[168:169], v5 offset:64
    ds_read_b64_tr_b16 a[170:171], v5 offset:576
    v_mfma_f32_16x16x32_bf16 v[196:199], a[208:211], v[144:147], v[196:199]
    v_exp_f32 v98, v98
    v_mfma_f32_16x16x32_bf16 v[200:203], a[212:215], v[144:147], v[200:203]
    buffer_load_dwordx4 v10, s[28:31], s85 offen nt lds
    v_mfma_f32_16x16x32_bf16 v[204:207], a[216:219], v[144:147], v[204:207]
    s_add_u32 m0, s89, 147744
    v_exp_f32 v99, v99
    v_mfma_f32_16x16x32_bf16 v[208:211], a[220:223], v[144:147], v[208:211]
    ds_read_b64_tr_b16 a[172:173], v5 offset:96
    ds_read_b64_tr_b16 a[174:175], v5 offset:608
    v_mfma_f32_16x16x32_bf16 v[112:115], a[128:131], v[28:31], v[76:79]
    v_exp_f32 v100, v100
    v_mfma_f32_16x16x32_bf16 v[112:115], a[132:135], v[32:35], v[112:115]
    buffer_load_dwordx4 v10, s[28:31], s85 offen offset:256 nt lds
    v_mfma_f32_16x16x32_bf16 v[112:115], a[136:139], v[36:39], v[112:115]
    s_add_u32 m0, s89, 148544
    v_exp_f32 v101, v101
    v_mfma_f32_16x16x32_bf16 v[112:115], a[140:143], v[40:43], v[112:115]
    ds_read_b64_tr_b16 a[176:177], v6 offset:0
    ds_read_b64_tr_b16 a[178:179], v6 offset:512
    v_mfma_f32_16x16x32_bf16 v[116:119], a[144:147], v[28:31], v[76:79]
    v_exp_f32 v102, v102
    v_mfma_f32_16x16x32_bf16 v[116:119], a[148:151], v[32:35], v[116:119]
    buffer_load_dwordx4 v10, s[28:31], s85 offen offset:512 nt lds
    v_mfma_f32_16x16x32_bf16 v[116:119], a[152:155], v[36:39], v[116:119]
    s_add_u32 m0, s89, 149344
    v_exp_f32 v103, v103
    v_mfma_f32_16x16x32_bf16 v[116:119], a[156:159], v[40:43], v[116:119]
    ds_read_b64_tr_b16 a[180:181], v6 offset:32
    ds_read_b64_tr_b16 a[182:183], v6 offset:544
    v_mfma_f32_16x16x32_bf16 v[120:123], a[128:131], v[44:47], v[80:83]
    v_exp_f32 v104, v104
    v_mfma_f32_16x16x32_bf16 v[120:123], a[132:135], v[48:51], v[120:123]
    buffer_load_dwordx4 v10, s[28:31], s85 offen offset:768 nt lds
    ds_read_b64_tr_b16 a[184:185], v6 offset:64
    ds_read_b64_tr_b16 a[186:187], v6 offset:576
    v_mfma_f32_16x16x32_bf16 v[120:123], a[136:139], v[52:55], v[120:123]
    buffer_load_dwordx2 v[24:25], off, s[16:19], s9 sc1
    v_mfma_f32_16x16x32_bf16 v[120:123], a[140:143], v[56:59], v[120:123]
    ds_read_b64_tr_b16 a[188:189], v6 offset:96
    ds_read_b64_tr_b16 a[190:191], v6 offset:608
    v_mfma_f32_16x16x32_bf16 v[124:127], a[144:147], v[44:47], v[80:83]
    v_exp_f32 v105, v105
    v_mfma_f32_16x16x32_bf16 v[124:127], a[148:151], v[48:51], v[124:127]
    ds_read_b64_tr_b16 a[192:193], v7 offset:0
    v_cvt_pk_bf16_f32 v132, v96, v97
    v_mfma_f32_16x16x32_bf16 v[124:127], a[152:155], v[52:55], v[124:127]
    v_exp_f32 v106, v106
    v_mfma_f32_16x16x32_bf16 v[124:127], a[156:159], v[56:59], v[124:127]
    s_waitcnt vmcnt(5) lgkmcnt(1)
    s_barrier
    s_add_u32 m0, s88, 96768
    v_mfma_f32_16x16x32_bf16 v[244:247], a[224:227], v[128:131], v[244:247]
    ds_read_b128 a[96:99], v1 offset:16640
    v_cvt_pk_bf16_f32 v133, v98, v99
    v_mfma_f32_16x16x32_bf16 v[148:151], a[160:163], v[128:131], v[148:151]
    v_exp_f32 v107, v107
    v_mfma_f32_16x16x32_bf16 v[152:155], a[164:167], v[128:131], v[152:155]
    ds_read_b128 a[100:103], v1 offset:16704
    v_cvt_pk_bf16_f32 v134, v100, v101
    v_mfma_f32_16x16x32_bf16 v[156:159], a[168:171], v[128:131], v[156:159]
    v_exp_f32 v108, v108
    v_mfma_f32_16x16x32_bf16 v[160:163], a[172:175], v[128:131], v[160:163]
    ds_read_b128 a[104:107], v2 offset:16640
    v_cvt_pk_bf16_f32 v135, v102, v103
    v_mfma_f32_16x16x32_bf16 v[164:167], a[176:179], v[128:131], v[164:167]
    v_exp_f32 v109, v109
    v_mfma_f32_16x16x32_bf16 v[168:171], a[180:183], v[128:131], v[168:171]
    ds_read_b128 a[108:111], v2 offset:16704
    v_cvt_pk_bf16_f32 v136, v104, v105
    v_mfma_f32_16x16x32_bf16 v[172:175], a[184:187], v[128:131], v[172:175]
    v_exp_f32 v110, v110
    v_mfma_f32_16x16x32_bf16 v[176:179], a[188:191], v[128:131], v[176:179]
    ds_read_b128 a[112:115], v1 offset:16896
    v_cvt_pk_bf16_f32 v137, v106, v107
    v_mfma_f32_16x16x32_bf16 v[248:251], a[224:227], v[132:135], v[248:251]
    v_exp_f32 v111, v111
    v_mfma_f32_16x16x32_bf16 v[180:183], a[160:163], v[132:135], v[180:183]
    ds_read_b128 a[116:119], v1 offset:16960
    v_cvt_pk_bf16_f32 v138, v108, v109
    v_mfma_f32_16x16x32_bf16 v[184:187], a[164:167], v[132:135], v[184:187]
    v_exp_f32 v112, v112
    v_mfma_f32_16x16x32_bf16 v[188:191], a[168:171], v[132:135], v[188:191]
    ds_read_b128 a[120:123], v2 offset:16896
    v_cvt_pk_bf16_f32 v139, v110, v111
    v_mfma_f32_16x16x32_bf16 v[192:195], a[172:175], v[132:135], v[192:195]
    v_exp_f32 v113, v113
    v_mfma_f32_16x16x32_bf16 v[196:199], a[176:179], v[132:135], v[196:199]
    ds_read_b64_tr_b16 a[194:195], v7 offset:512
    ds_read_b128 a[124:127], v2 offset:16960
    v_mfma_f32_16x16x32_bf16 v[200:203], a[180:183], v[132:135], v[200:203]
    v_exp_f32 v114, v114
    v_mfma_f32_16x16x32_bf16 v[204:207], a[184:187], v[132:135], v[204:207]
    ds_read_b64_tr_b16 a[196:197], v7 offset:32
    ds_read_b64_tr_b16 a[198:199], v7 offset:544
    v_mfma_f32_16x16x32_bf16 v[208:211], a[188:191], v[132:135], v[208:211]
    v_exp_f32 v115, v115
    v_mfma_f32_16x16x32_bf16 v[252:255], a[224:227], v[136:139], v[252:255]
    ds_read_b64_tr_b16 a[200:201], v7 offset:64
    ds_read_b64_tr_b16 a[202:203], v7 offset:576
    v_mfma_f32_16x16x32_bf16 v[212:215], a[160:163], v[136:139], v[212:215]
    v_exp_f32 v116, v116
    v_mfma_f32_16x16x32_bf16 v[216:219], a[164:167], v[136:139], v[216:219]
    ds_read_b64_tr_b16 a[204:205], v7 offset:96
    ds_read_b64_tr_b16 a[206:207], v7 offset:608
    v_mfma_f32_16x16x32_bf16 v[220:223], a[168:171], v[136:139], v[220:223]
    v_exp_f32 v117, v117
    v_mfma_f32_16x16x32_bf16 v[224:227], a[172:175], v[136:139], v[224:227]
    buffer_load_dwordx4 v9, s[24:27], s86 offen nt lds
    v_mfma_f32_16x16x32_bf16 v[228:231], a[176:179], v[136:139], v[228:231]
    s_add_u32 m0, s88, 98592
    v_exp_f32 v118, v118
    v_mfma_f32_16x16x32_bf16 v[232:235], a[180:183], v[136:139], v[232:235]
    ds_read_b64_tr_b16 a[208:209], v8 offset:0
    ds_read_b64_tr_b16 a[210:211], v8 offset:512
    v_mfma_f32_16x16x32_bf16 v[236:239], a[184:187], v[136:139], v[236:239]
    s_waitcnt lgkmcnt(2)
    v_exp_f32 v119, v119
    v_mfma_f32_16x16x32_bf16 v[240:243], a[188:191], v[136:139], v[240:243]
    buffer_load_dwordx4 v9, s[24:27], s86 offen offset:256 nt lds
    v_mfma_f32_16x16x32_bf16 v[88:91], a[96:99], v[28:31], v[76:79]
    s_add_u32 m0, s88, 100416
    v_exp_f32 v120, v120
    v_mfma_f32_16x16x32_bf16 v[88:91], a[100:103], v[32:35], v[88:91]
    ds_read_b64_tr_b16 a[212:213], v8 offset:32
    ds_read_b64_tr_b16 a[214:215], v8 offset:544
    v_mfma_f32_16x16x32_bf16 v[88:91], a[104:107], v[36:39], v[88:91]
    buffer_load_dwordx4 v9, s[24:27], s86 offen offset:512 nt lds
    v_mfma_f32_16x16x32_bf16 v[88:91], a[108:111], v[40:43], v[88:91]
    s_add_u32 m0, s88, 102240
    v_exp_f32 v121, v121
    v_mfma_f32_16x16x32_bf16 v[92:95], a[112:115], v[28:31], v[76:79]
    ds_read_b64_tr_b16 a[216:217], v8 offset:64
    v_cvt_pk_bf16_f32 v140, v112, v113
    v_mfma_f32_16x16x32_bf16 v[92:95], a[116:119], v[32:35], v[92:95]
    v_exp_f32 v122, v122
    v_mfma_f32_16x16x32_bf16 v[92:95], a[120:123], v[36:39], v[92:95]
    buffer_load_dwordx4 v9, s[24:27], s86 offen offset:768 nt lds
    v_mfma_f32_16x16x32_bf16 v[92:95], a[124:127], v[40:43], v[92:95]
    v_exp_f32 v123, v123
    v_mfma_f32_16x16x32_bf16 v[96:99], a[96:99], v[44:47], v[80:83]
    ds_read_b64_tr_b16 a[218:219], v8 offset:576
    v_cvt_pk_bf16_f32 v141, v114, v115
    v_mfma_f32_16x16x32_bf16 v[96:99], a[100:103], v[48:51], v[96:99]
    v_exp_f32 v124, v124
    v_mfma_f32_16x16x32_bf16 v[96:99], a[104:107], v[52:55], v[96:99]
    ds_read_b64_tr_b16 a[220:221], v8 offset:96
    v_cvt_pk_bf16_f32 v142, v116, v117
    v_mfma_f32_16x16x32_bf16 v[96:99], a[108:111], v[56:59], v[96:99]
    v_exp_f32 v125, v125
    v_mfma_f32_16x16x32_bf16 v[100:103], a[112:115], v[44:47], v[80:83]
    ds_read_b64_tr_b16 a[222:223], v8 offset:608
    v_cvt_pk_bf16_f32 v143, v118, v119
    v_mfma_f32_16x16x32_bf16 v[100:103], a[116:119], v[48:51], v[100:103]
    v_exp_f32 v126, v126
    v_mfma_f32_16x16x32_bf16 v[100:103], a[120:123], v[52:55], v[100:103]
    ds_read_b128 a[128:131], v3 offset:16640
    v_cvt_pk_bf16_f32 v144, v120, v121
    v_mfma_f32_16x16x32_bf16 v[100:103], a[124:127], v[56:59], v[100:103]
    v_exp_f32 v127, v127
    v_mfma_f32_16x16x32_bf16 v[104:107], a[96:99], v[60:63], v[84:87]
    ds_read_b128 a[132:135], v3 offset:16704
    v_cvt_pk_bf16_f32 v145, v122, v123
    v_mfma_f32_16x16x32_bf16 v[104:107], a[100:103], v[64:67], v[104:107]
    v_exp_f32 v88, v88
    v_mfma_f32_16x16x32_bf16 v[104:107], a[104:107], v[68:71], v[104:107]
    ds_read_b128 a[136:139], v4 offset:16640
    v_cvt_pk_bf16_f32 v146, v124, v125
    v_mfma_f32_16x16x32_bf16 v[104:107], a[108:111], v[72:75], v[104:107]
    v_exp_f32 v89, v89
    v_mfma_f32_16x16x32_bf16 v[108:111], a[112:115], v[60:63], v[84:87]
    ds_read_b128 a[140:143], v4 offset:16704
    v_cvt_pk_bf16_f32 v147, v126, v127
    v_mfma_f32_16x16x32_bf16 v[108:111], a[116:119], v[64:67], v[108:111]
    v_exp_f32 v90, v90
    v_mfma_f32_16x16x32_bf16 v[108:111], a[120:123], v[68:71], v[108:111]
    ds_read_b128 a[144:147], v3 offset:16896
    ds_read_b128 a[148:151], v3 offset:16960
    v_mfma_f32_16x16x32_bf16 v[108:111], a[124:127], v[72:75], v[108:111]
    v_exp_f32 v91, v91
    v_mfma_f32_16x16x32_bf16 v[244:247], a[224:227], v[140:143], v[244:247]
    ds_read_b128 a[152:155], v4 offset:16896
    ds_read_b128 a[156:159], v4 offset:16960
    v_mfma_f32_16x16x32_bf16 v[148:151], a[192:195], v[140:143], v[148:151]
    v_exp_f32 v92, v92
    v_mfma_f32_16x16x32_bf16 v[152:155], a[196:199], v[140:143], v[152:155]
    v_exp_f32 v93, v93
    v_mfma_f32_16x16x32_bf16 v[156:159], a[200:203], v[140:143], v[156:159]
    v_exp_f32 v94, v94
    v_mfma_f32_16x16x32_bf16 v[160:163], a[204:207], v[140:143], v[160:163]
    s_waitcnt lgkmcnt(0)
    v_exp_f32 v95, v95
    v_mfma_f32_16x16x32_bf16 v[164:167], a[208:211], v[140:143], v[164:167]
    v_cvt_pk_bf16_f32 v128, v88, v89
    v_cvt_pk_bf16_f32 v129, v90, v91
    v_mfma_f32_16x16x32_bf16 v[168:171], a[212:215], v[140:143], v[168:171]
    v_cvt_pk_bf16_f32 v130, v92, v93
    v_cvt_pk_bf16_f32 v131, v94, v95
    v_mfma_f32_16x16x32_bf16 v[172:175], a[216:219], v[140:143], v[172:175]
    v_exp_f32 v96, v96
    v_mfma_f32_16x16x32_bf16 v[176:179], a[220:223], v[140:143], v[176:179]
    s_waitcnt vmcnt(5)
    s_barrier
    s_add_u32 m0, s89, 130048
    v_mfma_f32_16x16x32_bf16 v[248:251], a[224:227], v[144:147], v[248:251]
    ds_read_b64_tr_b16 a[160:161], v5 offset:16896
    ds_read_b64_tr_b16 a[162:163], v5 offset:17408
    v_mfma_f32_16x16x32_bf16 v[180:183], a[192:195], v[144:147], v[180:183]
    v_exp_f32 v97, v97
    v_mfma_f32_16x16x32_bf16 v[184:187], a[196:199], v[144:147], v[184:187]
    ds_read_b64_tr_b16 a[164:165], v5 offset:16928
    ds_read_b64_tr_b16 a[166:167], v5 offset:17440
    v_mfma_f32_16x16x32_bf16 v[188:191], a[200:203], v[144:147], v[188:191]
    v_exp_f32 v98, v98
    v_mfma_f32_16x16x32_bf16 v[192:195], a[204:207], v[144:147], v[192:195]
    ds_read_b64_tr_b16 a[168:169], v5 offset:16960
    ds_read_b64_tr_b16 a[170:171], v5 offset:17472
    v_mfma_f32_16x16x32_bf16 v[196:199], a[208:211], v[144:147], v[196:199]
    v_exp_f32 v99, v99
    v_mfma_f32_16x16x32_bf16 v[200:203], a[212:215], v[144:147], v[200:203]
    buffer_load_dwordx4 v10, s[28:31], s86 offen nt lds
    v_mfma_f32_16x16x32_bf16 v[204:207], a[216:219], v[144:147], v[204:207]
    s_add_u32 m0, s89, 130848
    v_exp_f32 v100, v100
    v_mfma_f32_16x16x32_bf16 v[208:211], a[220:223], v[144:147], v[208:211]
    ds_read_b64_tr_b16 a[172:173], v5 offset:16992
    ds_read_b64_tr_b16 a[174:175], v5 offset:17504
    v_mfma_f32_16x16x32_bf16 v[112:115], a[128:131], v[28:31], v[76:79]
    v_exp_f32 v101, v101
    v_mfma_f32_16x16x32_bf16 v[112:115], a[132:135], v[32:35], v[112:115]
    buffer_load_dwordx4 v10, s[28:31], s86 offen offset:256 nt lds
    v_mfma_f32_16x16x32_bf16 v[112:115], a[136:139], v[36:39], v[112:115]
    s_add_u32 m0, s89, 131648
    v_exp_f32 v102, v102
    v_mfma_f32_16x16x32_bf16 v[112:115], a[140:143], v[40:43], v[112:115]
    ds_read_b64_tr_b16 a[176:177], v6 offset:16896
    ds_read_b64_tr_b16 a[178:179], v6 offset:17408
    v_mfma_f32_16x16x32_bf16 v[116:119], a[144:147], v[28:31], v[76:79]
    v_exp_f32 v103, v103
    v_mfma_f32_16x16x32_bf16 v[116:119], a[148:151], v[32:35], v[116:119]
    buffer_load_dwordx4 v10, s[28:31], s86 offen offset:512 nt lds
    v_mfma_f32_16x16x32_bf16 v[116:119], a[152:155], v[36:39], v[116:119]
    s_add_u32 m0, s89, 132448
    v_exp_f32 v104, v104
    v_mfma_f32_16x16x32_bf16 v[116:119], a[156:159], v[40:43], v[116:119]
    ds_read_b64_tr_b16 a[180:181], v6 offset:16928
    ds_read_b64_tr_b16 a[182:183], v6 offset:17440
    v_mfma_f32_16x16x32_bf16 v[120:123], a[128:131], v[44:47], v[80:83]
    v_exp_f32 v105, v105
    v_mfma_f32_16x16x32_bf16 v[120:123], a[132:135], v[48:51], v[120:123]
    buffer_load_dwordx4 v10, s[28:31], s86 offen offset:768 nt lds
    v_mfma_f32_16x16x32_bf16 v[120:123], a[136:139], v[52:55], v[120:123]
    ds_read_b64_tr_b16 a[184:185], v6 offset:16960
    ds_read_b64_tr_b16 a[186:187], v6 offset:17472
    v_mfma_f32_16x16x32_bf16 v[120:123], a[140:143], v[56:59], v[120:123]
    ds_read_b64_tr_b16 a[188:189], v6 offset:16992
    ds_read_b64_tr_b16 a[190:191], v6 offset:17504
    v_mfma_f32_16x16x32_bf16 v[124:127], a[144:147], v[44:47], v[80:83]
    v_exp_f32 v106, v106
    v_mfma_f32_16x16x32_bf16 v[124:127], a[148:151], v[48:51], v[124:127]
    ds_read_b64_tr_b16 a[192:193], v7 offset:16896
    v_cvt_pk_bf16_f32 v132, v96, v97
    v_mfma_f32_16x16x32_bf16 v[124:127], a[152:155], v[52:55], v[124:127]
    v_exp_f32 v107, v107
    v_mfma_f32_16x16x32_bf16 v[124:127], a[156:159], v[56:59], v[124:127]
    s_waitcnt vmcnt(4) lgkmcnt(1)
    s_barrier
    s_add_u32 m0, s88, 113408
    v_mfma_f32_16x16x32_bf16 v[244:247], a[224:227], v[128:131], v[244:247]
    ds_read_b128 a[96:99], v1 offset:0
    v_cvt_pk_bf16_f32 v133, v98, v99
    v_mfma_f32_16x16x32_bf16 v[148:151], a[160:163], v[128:131], v[148:151]
    v_exp_f32 v108, v108
    v_mfma_f32_16x16x32_bf16 v[152:155], a[164:167], v[128:131], v[152:155]
    ds_read_b128 a[100:103], v1 offset:64
    v_cvt_pk_bf16_f32 v134, v100, v101
    v_mfma_f32_16x16x32_bf16 v[156:159], a[168:171], v[128:131], v[156:159]
    v_exp_f32 v109, v109
    v_mfma_f32_16x16x32_bf16 v[160:163], a[172:175], v[128:131], v[160:163]
    ds_read_b128 a[104:107], v2 offset:0
    v_cvt_pk_bf16_f32 v135, v102, v103
    v_mfma_f32_16x16x32_bf16 v[164:167], a[176:179], v[128:131], v[164:167]
    v_exp_f32 v110, v110
    v_mfma_f32_16x16x32_bf16 v[168:171], a[180:183], v[128:131], v[168:171]
    ds_read_b128 a[108:111], v2 offset:64
    v_cvt_pk_bf16_f32 v136, v104, v105
    v_mfma_f32_16x16x32_bf16 v[172:175], a[184:187], v[128:131], v[172:175]
    v_exp_f32 v111, v111
    v_mfma_f32_16x16x32_bf16 v[176:179], a[188:191], v[128:131], v[176:179]
    ds_read_b128 a[112:115], v1 offset:256
    v_cvt_pk_bf16_f32 v137, v106, v107
    v_mfma_f32_16x16x32_bf16 v[248:251], a[224:227], v[132:135], v[248:251]
    v_exp_f32 v112, v112
    v_mfma_f32_16x16x32_bf16 v[180:183], a[160:163], v[132:135], v[180:183]
    ds_read_b128 a[116:119], v1 offset:320
    v_cvt_pk_bf16_f32 v138, v108, v109
    v_mfma_f32_16x16x32_bf16 v[184:187], a[164:167], v[132:135], v[184:187]
    v_exp_f32 v113, v113
    v_mfma_f32_16x16x32_bf16 v[188:191], a[168:171], v[132:135], v[188:191]
    ds_read_b128 a[120:123], v2 offset:256
    v_cvt_pk_bf16_f32 v139, v110, v111
    v_mfma_f32_16x16x32_bf16 v[192:195], a[172:175], v[132:135], v[192:195]
    v_exp_f32 v114, v114
    v_mfma_f32_16x16x32_bf16 v[196:199], a[176:179], v[132:135], v[196:199]
    ds_read_b64_tr_b16 a[194:195], v7 offset:17408
    ds_read_b128 a[124:127], v2 offset:320
    v_mfma_f32_16x16x32_bf16 v[200:203], a[180:183], v[132:135], v[200:203]
    v_exp_f32 v115, v115
    v_mfma_f32_16x16x32_bf16 v[204:207], a[184:187], v[132:135], v[204:207]
    ds_read_b64_tr_b16 a[196:197], v7 offset:16928
    ds_read_b64_tr_b16 a[198:199], v7 offset:17440
    v_mfma_f32_16x16x32_bf16 v[208:211], a[188:191], v[132:135], v[208:211]
    v_exp_f32 v116, v116
    v_mfma_f32_16x16x32_bf16 v[252:255], a[224:227], v[136:139], v[252:255]
    ds_read_b64_tr_b16 a[200:201], v7 offset:16960
    ds_read_b64_tr_b16 a[202:203], v7 offset:17472
    v_mfma_f32_16x16x32_bf16 v[212:215], a[160:163], v[136:139], v[212:215]
    v_exp_f32 v117, v117
    v_mfma_f32_16x16x32_bf16 v[216:219], a[164:167], v[136:139], v[216:219]
    ds_read_b64_tr_b16 a[204:205], v7 offset:16992
    ds_read_b64_tr_b16 a[206:207], v7 offset:17504
    v_mfma_f32_16x16x32_bf16 v[220:223], a[168:171], v[136:139], v[220:223]
    v_exp_f32 v118, v118
    v_mfma_f32_16x16x32_bf16 v[224:227], a[172:175], v[136:139], v[224:227]
    buffer_load_dwordx4 v9, s[24:27], s87 offen nt lds
    v_mfma_f32_16x16x32_bf16 v[228:231], a[176:179], v[136:139], v[228:231]
    s_add_u32 m0, s88, 115232
    v_exp_f32 v119, v119
    v_mfma_f32_16x16x32_bf16 v[232:235], a[180:183], v[136:139], v[232:235]
    ds_read_b64_tr_b16 a[208:209], v8 offset:16896
    ds_read_b64_tr_b16 a[210:211], v8 offset:17408
    v_mfma_f32_16x16x32_bf16 v[236:239], a[184:187], v[136:139], v[236:239]
    s_waitcnt lgkmcnt(2)
    v_exp_f32 v120, v120
    v_mfma_f32_16x16x32_bf16 v[240:243], a[188:191], v[136:139], v[240:243]
    buffer_load_dwordx4 v9, s[24:27], s87 offen offset:256 nt lds
    v_mfma_f32_16x16x32_bf16 v[88:91], a[96:99], v[28:31], v[76:79]
    s_add_u32 m0, s88, 117056
    v_exp_f32 v121, v121
    v_mfma_f32_16x16x32_bf16 v[88:91], a[100:103], v[32:35], v[88:91]
    ds_read_b64_tr_b16 a[212:213], v8 offset:16928
    ds_read_b64_tr_b16 a[214:215], v8 offset:17440
    v_mfma_f32_16x16x32_bf16 v[88:91], a[104:107], v[36:39], v[88:91]
    v_exp_f32 v122, v122
    v_mfma_f32_16x16x32_bf16 v[88:91], a[108:111], v[40:43], v[88:91]
    buffer_load_dwordx4 v9, s[24:27], s87 offen offset:512 nt lds
    v_mfma_f32_16x16x32_bf16 v[92:95], a[112:115], v[28:31], v[76:79]
    s_add_u32 m0, s88, 118880
    v_exp_f32 v123, v123
    v_mfma_f32_16x16x32_bf16 v[92:95], a[116:119], v[32:35], v[92:95]
    ds_read_b64_tr_b16 a[216:217], v8 offset:16960
    v_cvt_pk_bf16_f32 v140, v112, v113
    v_mfma_f32_16x16x32_bf16 v[92:95], a[120:123], v[36:39], v[92:95]
    v_exp_f32 v124, v124
    v_mfma_f32_16x16x32_bf16 v[92:95], a[124:127], v[40:43], v[92:95]
    buffer_load_dwordx4 v9, s[24:27], s87 offen offset:768 nt lds
    v_mfma_f32_16x16x32_bf16 v[96:99], a[96:99], v[44:47], v[80:83]
    v_exp_f32 v125, v125
    v_mfma_f32_16x16x32_bf16 v[96:99], a[100:103], v[48:51], v[96:99]
    ds_read_b64_tr_b16 a[218:219], v8 offset:17472
    v_cvt_pk_bf16_f32 v141, v114, v115
    v_mfma_f32_16x16x32_bf16 v[96:99], a[104:107], v[52:55], v[96:99]
    v_exp_f32 v126, v126
    v_mfma_f32_16x16x32_bf16 v[96:99], a[108:111], v[56:59], v[96:99]
    ds_read_b64_tr_b16 a[220:221], v8 offset:16992
    v_cvt_pk_bf16_f32 v142, v116, v117
    v_mfma_f32_16x16x32_bf16 v[100:103], a[112:115], v[44:47], v[80:83]
    v_exp_f32 v127, v127
    v_mfma_f32_16x16x32_bf16 v[100:103], a[116:119], v[48:51], v[100:103]
    ds_read_b64_tr_b16 a[222:223], v8 offset:17504
    v_cvt_pk_bf16_f32 v143, v118, v119
    v_mfma_f32_16x16x32_bf16 v[100:103], a[120:123], v[52:55], v[100:103]
    v_exp_f32 v88, v88
    v_mfma_f32_16x16x32_bf16 v[100:103], a[124:127], v[56:59], v[100:103]
    ds_read_b128 a[128:131], v3 offset:0
    v_cvt_pk_bf16_f32 v144, v120, v121
    v_mfma_f32_16x16x32_bf16 v[104:107], a[96:99], v[60:63], v[84:87]
    v_exp_f32 v89, v89
    v_mfma_f32_16x16x32_bf16 v[104:107], a[100:103], v[64:67], v[104:107]
    ds_read_b128 a[132:135], v3 offset:64
    v_cvt_pk_bf16_f32 v145, v122, v123
    v_mfma_f32_16x16x32_bf16 v[104:107], a[104:107], v[68:71], v[104:107]
    v_exp_f32 v90, v90
    v_mfma_f32_16x16x32_bf16 v[104:107], a[108:111], v[72:75], v[104:107]
    ds_read_b128 a[136:139], v4 offset:0
    v_cvt_pk_bf16_f32 v146, v124, v125
    v_mfma_f32_16x16x32_bf16 v[108:111], a[112:115], v[60:63], v[84:87]
    v_exp_f32 v91, v91
    v_mfma_f32_16x16x32_bf16 v[108:111], a[116:119], v[64:67], v[108:111]
    ds_read_b128 a[140:143], v4 offset:64
    v_cvt_pk_bf16_f32 v147, v126, v127
    v_mfma_f32_16x16x32_bf16 v[108:111], a[120:123], v[68:71], v[108:111]
    v_exp_f32 v92, v92
    v_mfma_f32_16x16x32_bf16 v[108:111], a[124:127], v[72:75], v[108:111]
    ds_read_b128 a[144:147], v3 offset:256
    ds_read_b128 a[148:151], v3 offset:320
    v_mfma_f32_16x16x32_bf16 v[244:247], a[224:227], v[140:143], v[244:247]
    v_exp_f32 v93, v93
    v_mfma_f32_16x16x32_bf16 v[148:151], a[192:195], v[140:143], v[148:151]
    ds_read_b128 a[152:155], v4 offset:256
    ds_read_b128 a[156:159], v4 offset:320
    v_mfma_f32_16x16x32_bf16 v[152:155], a[196:199], v[140:143], v[152:155]
    v_exp_f32 v94, v94
    v_mfma_f32_16x16x32_bf16 v[156:159], a[200:203], v[140:143], v[156:159]
    v_exp_f32 v95, v95
    v_mfma_f32_16x16x32_bf16 v[160:163], a[204:207], v[140:143], v[160:163]
    s_waitcnt lgkmcnt(2)
    v_cvt_pk_bf16_f32 v128, v88, v89
    v_cvt_pk_bf16_f32 v129, v90, v91
    v_mfma_f32_16x16x32_bf16 v[164:167], a[208:211], v[140:143], v[164:167]
    v_cvt_pk_bf16_f32 v130, v92, v93
    v_cvt_pk_bf16_f32 v131, v94, v95
    v_mfma_f32_16x16x32_bf16 v[168:171], a[212:215], v[140:143], v[168:171]
    v_exp_f32 v96, v96
    v_mfma_f32_16x16x32_bf16 v[172:175], a[216:219], v[140:143], v[172:175]
    v_exp_f32 v97, v97
    v_mfma_f32_16x16x32_bf16 v[176:179], a[220:223], v[140:143], v[176:179]
    v_cmp_ne_u16 vcc, 0xffff, v24
    s_nop 1
    s_cbranch_vccnz L_spin_rdy
L_back_rdy:
    v_readfirstlane_b32 s9, v24
    s_waitcnt vmcnt(4) lgkmcnt(0)
    s_barrier
    s_add_u32 m0, s89, 146944
    v_mfma_f32_16x16x32_bf16 v[248:251], a[224:227], v[144:147], v[248:251]
    ds_read_b64_tr_b16 a[160:161], v5 offset:0
    v_readfirstlane_b32 s0, v25
    v_mfma_f32_16x16x32_bf16 v[180:183], a[192:195], v[144:147], v[180:183]
    s_bcnt1_i32_b32 s9, s9
    v_exp_f32 v98, v98
    v_mfma_f32_16x16x32_bf16 v[184:187], a[196:199], v[144:147], v[184:187]
    ds_read_b64_tr_b16 a[162:163], v5 offset:512
    ds_read_b64_tr_b16 a[164:165], v5 offset:32
    v_mfma_f32_16x16x32_bf16 v[188:191], a[200:203], v[144:147], v[188:191]
    s_sub_u32 s9, s9, 24
    v_exp_f32 v99, v99
    v_mfma_f32_16x16x32_bf16 v[192:195], a[204:207], v[144:147], v[192:195]
    ds_read_b64_tr_b16 a[166:167], v5 offset:544
    ds_read_b64_tr_b16 a[168:169], v5 offset:64
    v_mfma_f32_16x16x32_bf16 v[196:199], a[208:211], v[144:147], v[196:199]
    s_ashr_i32 s9, s9, 31
    v_exp_f32 v100, v100
    v_mfma_f32_16x16x32_bf16 v[200:203], a[212:215], v[144:147], v[200:203]
    buffer_load_dwordx4 v10, s[28:31], s87 offen nt lds
    v_mfma_f32_16x16x32_bf16 v[204:207], a[216:219], v[144:147], v[204:207]
    s_add_u32 m0, s89, 147744
    v_exp_f32 v101, v101
    v_mfma_f32_16x16x32_bf16 v[208:211], a[220:223], v[144:147], v[208:211]
    ds_read_b64_tr_b16 a[170:171], v5 offset:576
    ds_read_b64_tr_b16 a[172:173], v5 offset:96
    v_mfma_f32_16x16x32_bf16 v[112:115], a[128:131], v[28:31], v[76:79]
    s_xor_b32 s0, s0, s9
    v_exp_f32 v102, v102
    v_mfma_f32_16x16x32_bf16 v[112:115], a[132:135], v[32:35], v[112:115]
    buffer_load_dwordx4 v10, s[28:31], s87 offen offset:256 nt lds
    v_mfma_f32_16x16x32_bf16 v[112:115], a[136:139], v[36:39], v[112:115]
    s_add_u32 m0, s89, 148544
    v_exp_f32 v103, v103
    v_mfma_f32_16x16x32_bf16 v[112:115], a[140:143], v[40:43], v[112:115]
    ds_read_b64_tr_b16 a[174:175], v5 offset:608
    ds_read_b64_tr_b16 a[176:177], v6 offset:0
    v_mfma_f32_16x16x32_bf16 v[116:119], a[144:147], v[28:31], v[76:79]
    ds_read_b64_tr_b16 a[178:179], v6 offset:512
    ds_read_b64_tr_b16 a[180:181], v6 offset:32
    v_mfma_f32_16x16x32_bf16 v[116:119], a[148:151], v[32:35], v[116:119]
    buffer_load_dwordx4 v10, s[28:31], s87 offen offset:512 nt lds
    v_mfma_f32_16x16x32_bf16 v[116:119], a[152:155], v[36:39], v[116:119]
    s_add_u32 m0, s89, 149344
    v_exp_f32 v104, v104
    v_mfma_f32_16x16x32_bf16 v[116:119], a[156:159], v[40:43], v[116:119]
    ds_read_b64_tr_b16 a[182:183], v6 offset:544
    ds_read_b64_tr_b16 a[184:185], v6 offset:64
    v_mfma_f32_16x16x32_bf16 v[120:123], a[128:131], v[44:47], v[80:83]
    ds_read_b64_tr_b16 a[186:187], v6 offset:576
    ds_read_b64_tr_b16 a[188:189], v6 offset:96
    v_mfma_f32_16x16x32_bf16 v[120:123], a[132:135], v[48:51], v[120:123]
    buffer_load_dwordx4 v10, s[28:31], s87 offen offset:768 nt lds
    ds_read_b64_tr_b16 a[190:191], v6 offset:608
    v_mfma_f32_16x16x32_bf16 v[120:123], a[136:139], v[52:55], v[120:123]
    s_xor_b32 s9, s45, 0
    v_exp_f32 v105, v105
    v_mfma_f32_16x16x32_bf16 v[120:123], a[140:143], v[56:59], v[120:123]
    ds_read_b64_tr_b16 a[192:193], v7 offset:0
    v_cvt_pk_bf16_f32 v132, v96, v97
    v_mfma_f32_16x16x32_bf16 v[124:127], a[144:147], v[44:47], v[80:83]
    s_lshr_b32 s9, s0, s9
    v_exp_f32 v106, v106
    v_mfma_f32_16x16x32_bf16 v[124:127], a[148:151], v[48:51], v[124:127]
    ds_read_b64_tr_b16 a[194:195], v7 offset:512
    v_cvt_pk_bf16_f32 v133, v98, v99
    v_mfma_f32_16x16x32_bf16 v[124:127], a[152:155], v[52:55], v[124:127]
    s_and_b32 s9, s9, 1
    v_exp_f32 v107, v107
    v_mfma_f32_16x16x32_bf16 v[124:127], a[156:159], v[56:59], v[124:127]
    s_waitcnt vmcnt(4) lgkmcnt(1)
    s_barrier
    s_add_u32 m0, s92, 0
    v_mfma_f32_16x16x32_bf16 v[244:247], a[224:227], v[128:131], v[244:247]
    ds_read_b128 a[96:99], v1 offset:16640
    v_cvt_pk_bf16_f32 v134, v100, v101
    v_mfma_f32_16x16x32_bf16 v[148:151], a[160:163], v[128:131], v[148:151]
    s_add_u32 s5, s71, 8192
    v_exp_f32 v108, v108
    v_mfma_f32_16x16x32_bf16 v[152:155], a[164:167], v[128:131], v[152:155]
    buffer_load_dwordx4 v11, s[36:39], s71 offen lds
    v_mfma_f32_16x16x32_bf16 v[156:159], a[168:171], v[128:131], v[156:159]
    s_add_u32 s4, s71, 16384
    v_cvt_pk_bf16_f32 v135, v102, v103
    v_cvt_pk_bf16_f32 v136, v104, v105
    v_mfma_f32_16x16x32_bf16 v[160:163], a[172:175], v[128:131], v[160:163]
    ds_read_b128 a[100:103], v1 offset:16704
    v_cvt_pk_bf16_f32 v137, v106, v107
    v_mfma_f32_16x16x32_bf16 v[164:167], a[176:179], v[128:131], v[164:167]
    s_lshl_b32 s9, s9, 13
    v_exp_f32 v109, v109
    v_mfma_f32_16x16x32_bf16 v[168:171], a[180:183], v[128:131], v[168:171]
    buffer_load_dwordx4 v11, s[36:39], s5 offen offset:1024 lds
    v_mfma_f32_16x16x32_bf16 v[172:175], a[184:187], v[128:131], v[172:175]
    s_add_u32 s5, s71, 24576
    v_exp_f32 v110, v110
    v_mfma_f32_16x16x32_bf16 v[176:179], a[188:191], v[128:131], v[176:179]
    ds_read_b128 a[104:107], v2 offset:16640
    v_cvt_pk_bf16_f32 v138, v108, v109
    v_mfma_f32_16x16x32_bf16 v[248:251], a[224:227], v[132:135], v[248:251]
    s_xor_b32 s93, s80, 0
    v_exp_f32 v111, v111
    v_mfma_f32_16x16x32_bf16 v[180:183], a[160:163], v[132:135], v[180:183]
    buffer_load_dwordx4 v11, s[36:39], s4 offen offset:2048 lds
    v_mfma_f32_16x16x32_bf16 v[184:187], a[164:167], v[132:135], v[184:187]
    s_add_u32 s4, s71, 36864
    v_exp_f32 v112, v112
    v_mfma_f32_16x16x32_bf16 v[188:191], a[168:171], v[132:135], v[188:191]
    ds_read_b128 a[108:111], v2 offset:16704
    v_cvt_pk_bf16_f32 v139, v110, v111
    v_mfma_f32_16x16x32_bf16 v[192:195], a[172:175], v[132:135], v[192:195]
    s_add_u32 s93, s93, s9
    v_exp_f32 v113, v113
    v_mfma_f32_16x16x32_bf16 v[196:199], a[176:179], v[132:135], v[196:199]
    buffer_load_dwordx4 v11, s[36:39], s5 offen offset:3072 lds
    v_mfma_f32_16x16x32_bf16 v[200:203], a[180:183], v[132:135], v[200:203]
    s_add_u32 m0, s92, 4096
    v_exp_f32 v114, v114
    v_mfma_f32_16x16x32_bf16 v[204:207], a[184:187], v[132:135], v[204:207]
    ds_read_b128 a[112:115], v1 offset:16896
    ds_read_b128 a[116:119], v1 offset:16960
    v_mfma_f32_16x16x32_bf16 v[208:211], a[188:191], v[132:135], v[208:211]
    s_add_u32 s5, s71, 45056
    v_exp_f32 v115, v115
    v_mfma_f32_16x16x32_bf16 v[252:255], a[224:227], v[136:139], v[252:255]
    buffer_load_dwordx4 v11, s[36:39], s4 offen lds
    ds_read_b128 a[120:123], v2 offset:16896
    ds_read_b128 a[124:127], v2 offset:16960
    v_mfma_f32_16x16x32_bf16 v[212:215], a[160:163], v[136:139], v[212:215]
    s_add_u32 s4, s71, 53248
    v_exp_f32 v116, v116
    v_mfma_f32_16x16x32_bf16 v[216:219], a[164:167], v[136:139], v[216:219]
    ds_read_b64_tr_b16 a[196:197], v7 offset:32
    ds_read_b64_tr_b16 a[198:199], v7 offset:544
    v_mfma_f32_16x16x32_bf16 v[220:223], a[168:171], v[136:139], v[220:223]
    s_xor_b32 s9, s45, 1
    v_exp_f32 v117, v117
    v_mfma_f32_16x16x32_bf16 v[224:227], a[172:175], v[136:139], v[224:227]
    buffer_load_dwordx4 v11, s[36:39], s5 offen offset:1024 lds
    v_mfma_f32_16x16x32_bf16 v[228:231], a[176:179], v[136:139], v[228:231]
    s_add_u32 s5, s71, 61440
    v_exp_f32 v118, v118
    v_mfma_f32_16x16x32_bf16 v[232:235], a[180:183], v[136:139], v[232:235]
    ds_read_b64_tr_b16 a[200:201], v7 offset:64
    ds_read_b64_tr_b16 a[202:203], v7 offset:576
    v_mfma_f32_16x16x32_bf16 v[236:239], a[184:187], v[136:139], v[236:239]
    s_lshr_b32 s9, s0, s9
    v_exp_f32 v119, v119
    v_mfma_f32_16x16x32_bf16 v[240:243], a[188:191], v[136:139], v[240:243]
    buffer_load_dwordx4 v11, s[36:39], s4 offen offset:2048 lds
    s_waitcnt lgkmcnt(2)
    v_mfma_f32_16x16x32_bf16 v[104:107], a[96:99], v[60:63], v[84:87]
    s_and_b32 s9, s9, 1
    v_exp_f32 v120, v120
    v_mfma_f32_16x16x32_bf16 v[104:107], a[100:103], v[64:67], v[104:107]
    ds_read_b64_tr_b16 a[204:205], v7 offset:96
    ds_read_b64_tr_b16 a[206:207], v7 offset:608
    v_mfma_f32_16x16x32_bf16 v[104:107], a[104:107], v[68:71], v[104:107]
    s_lshl_b32 s9, s9, 13
    v_exp_f32 v121, v121
    v_mfma_f32_16x16x32_bf16 v[104:107], a[108:111], v[72:75], v[104:107]
    s_xor_b32 s47, s80, 131072
    v_exp_f32 v122, v122
    v_mfma_f32_16x16x32_bf16 v[108:111], a[112:115], v[60:63], v[84:87]
    buffer_load_dwordx4 v11, s[36:39], s5 offen offset:3072 lds
    v_exp_f32 v123, v123
    v_mfma_f32_16x16x32_bf16 v[108:111], a[116:119], v[64:67], v[108:111]
    s_add_u32 s47, s47, s9
    v_exp_f32 v124, v124
    v_mfma_f32_16x16x32_bf16 v[108:111], a[120:123], v[68:71], v[108:111]
    ds_read_b64_tr_b16 a[208:209], v8 offset:0
    ds_read_b64_tr_b16 a[210:211], v8 offset:512
    v_mfma_f32_16x16x32_bf16 v[108:111], a[124:127], v[72:75], v[108:111]
    s_add_u32 s10, s47, 0
    v_exp_f32 v125, v125
    v_mfma_f32_16x16x32_bf16 v[88:91], a[96:99], v[28:31], v[76:79]
    s_add_u32 s11, s47, 4096
    v_exp_f32 v126, v126
    v_mfma_f32_16x16x32_bf16 v[88:91], a[100:103], v[32:35], v[88:91]
    v_exp_f32 v127, v127
    v_mfma_f32_16x16x32_bf16 v[88:91], a[104:107], v[36:39], v[88:91]
    ds_read_b64_tr_b16 a[212:213], v8 offset:32
    ds_read_b64_tr_b16 a[214:215], v8 offset:544
    v_mfma_f32_16x16x32_bf16 v[88:91], a[108:111], v[40:43], v[88:91]
    v_exp_f32 v104, v104
    v_mfma_f32_16x16x32_bf16 v[92:95], a[112:115], v[28:31], v[76:79]
    ds_read_b64_tr_b16 a[216:217], v8 offset:64
    v_cvt_pk_bf16_f32 v140, v112, v113
    v_mfma_f32_16x16x32_bf16 v[92:95], a[116:119], v[32:35], v[92:95]
    v_cvt_pk_bf16_f32 v141, v114, v115
    v_cvt_pk_bf16_f32 v142, v116, v117
    v_mfma_f32_16x16x32_bf16 v[92:95], a[120:123], v[36:39], v[92:95]
    ds_read_b64_tr_b16 a[218:219], v8 offset:576
    v_cvt_pk_bf16_f32 v143, v118, v119
    v_mfma_f32_16x16x32_bf16 v[92:95], a[124:127], v[40:43], v[92:95]
    v_exp_f32 v105, v105
    v_mfma_f32_16x16x32_bf16 v[96:99], a[96:99], v[44:47], v[80:83]
    ds_read_b64_tr_b16 a[220:221], v8 offset:96
    ds_read_b64_tr_b16 a[222:223], v8 offset:608
    v_mfma_f32_16x16x32_bf16 v[96:99], a[100:103], v[48:51], v[96:99]
    v_cvt_pk_bf16_f32 v144, v120, v121
    v_cvt_pk_bf16_f32 v145, v122, v123
    v_mfma_f32_16x16x32_bf16 v[96:99], a[104:107], v[52:55], v[96:99]
    ds_read_b128 a[128:131], v3 offset:16640
    v_cvt_pk_bf16_f32 v146, v124, v125
    v_mfma_f32_16x16x32_bf16 v[96:99], a[108:111], v[56:59], v[96:99]
    ds_read_b128 a[132:135], v3 offset:16704
    v_cvt_pk_bf16_f32 v147, v126, v127
    v_mfma_f32_16x16x32_bf16 v[100:103], a[112:115], v[44:47], v[80:83]
    v_exp_f32 v106, v106
    v_mfma_f32_16x16x32_bf16 v[100:103], a[116:119], v[48:51], v[100:103]
    ds_read_b128 a[136:139], v4 offset:16640
    ds_read_b128 a[140:143], v4 offset:16704
    v_mfma_f32_16x16x32_bf16 v[100:103], a[120:123], v[52:55], v[100:103]
    ds_read_b128 a[144:147], v3 offset:16896
    ds_read_b128 a[148:151], v3 offset:16960
    v_mfma_f32_16x16x32_bf16 v[100:103], a[124:127], v[56:59], v[100:103]
    ds_read_b128 a[152:155], v4 offset:16896
    ds_read_b128 a[156:159], v4 offset:16960
    v_mfma_f32_16x16x32_bf16 v[244:247], a[224:227], v[140:143], v[244:247]
    v_exp_f32 v107, v107
    v_mfma_f32_16x16x32_bf16 v[148:151], a[192:195], v[140:143], v[148:151]
    v_exp_f32 v108, v108
    v_mfma_f32_16x16x32_bf16 v[152:155], a[196:199], v[140:143], v[152:155]
    s_waitcnt lgkmcnt(2)
    v_exp_f32 v109, v109
    v_mfma_f32_16x16x32_bf16 v[156:159], a[200:203], v[140:143], v[156:159]
    v_exp_f32 v110, v110
    v_mfma_f32_16x16x32_bf16 v[160:163], a[204:207], v[140:143], v[160:163]
    v_exp_f32 v111, v111
    v_mfma_f32_16x16x32_bf16 v[164:167], a[208:211], v[140:143], v[164:167]
    v_exp_f32 v88, v88
    v_mfma_f32_16x16x32_bf16 v[168:171], a[212:215], v[140:143], v[168:171]
    v_exp_f32 v89, v89
    v_mfma_f32_16x16x32_bf16 v[172:175], a[216:219], v[140:143], v[172:175]
    v_exp_f32 v90, v90
    v_mfma_f32_16x16x32_bf16 v[176:179], a[220:223], v[140:143], v[176:179]
    v_exp_f32 v91, v91
    v_mfma_f32_16x16x32_bf16 v[248:251], a[224:227], v[144:147], v[248:251]
    v_exp_f32 v92, v92
    v_mfma_f32_16x16x32_bf16 v[180:183], a[192:195], v[144:147], v[180:183]
    v_exp_f32 v93, v93
    v_mfma_f32_16x16x32_bf16 v[184:187], a[196:199], v[144:147], v[184:187]
    v_exp_f32 v94, v94
    v_mfma_f32_16x16x32_bf16 v[188:191], a[200:203], v[144:147], v[188:191]
    v_exp_f32 v95, v95
    v_mfma_f32_16x16x32_bf16 v[192:195], a[204:207], v[144:147], v[192:195]
    v_exp_f32 v96, v96
    v_mfma_f32_16x16x32_bf16 v[196:199], a[208:211], v[144:147], v[196:199]
    v_exp_f32 v97, v97
    v_mfma_f32_16x16x32_bf16 v[200:203], a[212:215], v[144:147], v[200:203]
    v_exp_f32 v98, v98
    v_mfma_f32_16x16x32_bf16 v[204:207], a[216:219], v[144:147], v[204:207]
    v_exp_f32 v99, v99
    v_mfma_f32_16x16x32_bf16 v[208:211], a[220:223], v[144:147], v[208:211]
    v_exp_f32 v100, v100
    v_mfma_f32_16x16x32_bf16 v[112:115], a[128:131], v[28:31], v[76:79]
    v_exp_f32 v101, v101
    v_mfma_f32_16x16x32_bf16 v[112:115], a[132:135], v[32:35], v[112:115]
    v_exp_f32 v102, v102
    v_mfma_f32_16x16x32_bf16 v[112:115], a[136:139], v[36:39], v[112:115]
    v_exp_f32 v103, v103
    v_mfma_f32_16x16x32_bf16 v[112:115], a[140:143], v[40:43], v[112:115]
    v_cvt_pk_bf16_f32 v136, v104, v105
    v_cvt_pk_bf16_f32 v137, v106, v107
    v_mfma_f32_16x16x32_bf16 v[116:119], a[144:147], v[28:31], v[76:79]
    v_cvt_pk_bf16_f32 v138, v108, v109
    v_cvt_pk_bf16_f32 v139, v110, v111
    v_mfma_f32_16x16x32_bf16 v[116:119], a[148:151], v[32:35], v[116:119]
    s_waitcnt lgkmcnt(0)
    v_cvt_pk_bf16_f32 v128, v88, v89
    v_cvt_pk_bf16_f32 v129, v90, v91
    v_mfma_f32_16x16x32_bf16 v[116:119], a[152:155], v[36:39], v[116:119]
    v_exp_f32 v115, v115
    v_mfma_f32_16x16x32_bf16 v[116:119], a[156:159], v[40:43], v[116:119]
    v_exp_f32 v112, v112
    v_mfma_f32_16x16x32_bf16 v[120:123], a[128:131], v[44:47], v[80:83]
    v_exp_f32 v113, v113
    v_mfma_f32_16x16x32_bf16 v[120:123], a[132:135], v[48:51], v[120:123]
    v_exp_f32 v114, v114
    v_mfma_f32_16x16x32_bf16 v[120:123], a[136:139], v[52:55], v[120:123]
    v_cvt_pk_bf16_f32 v130, v92, v93
    v_cvt_pk_bf16_f32 v131, v94, v95
    v_exp_f32 v116, v116
    v_mfma_f32_16x16x32_bf16 v[120:123], a[140:143], v[56:59], v[120:123]
    v_cvt_pk_bf16_f32 v132, v96, v97
    v_cvt_pk_bf16_f32 v133, v98, v99
    v_exp_f32 v117, v117
    v_mfma_f32_16x16x32_bf16 v[124:127], a[144:147], v[44:47], v[80:83]
    v_cvt_pk_bf16_f32 v134, v100, v101
    v_cvt_pk_bf16_f32 v135, v102, v103
    v_exp_f32 v118, v118
    v_mfma_f32_16x16x32_bf16 v[124:127], a[148:151], v[48:51], v[124:127]
    v_cvt_pk_bf16_f32 v140, v112, v113
    v_cvt_pk_bf16_f32 v141, v114, v115
    v_exp_f32 v119, v119
    v_mfma_f32_16x16x32_bf16 v[124:127], a[152:155], v[52:55], v[124:127]
    v_cvt_pk_bf16_f32 v142, v116, v117
    v_cvt_pk_bf16_f32 v143, v118, v119
    v_exp_f32 v120, v120
    v_exp_f32 v121, v121
    v_exp_f32 v122, v122
    v_exp_f32 v123, v123
    v_mfma_f32_16x16x32_bf16 v[124:127], a[156:159], v[56:59], v[124:127]
    v_cvt_pk_bf16_f32 v144, v120, v121
    v_cvt_pk_bf16_f32 v145, v122, v123
    s_nop 5
    v_exp_f32 v124, v124
    v_exp_f32 v125, v125
    v_exp_f32 v126, v126
    v_exp_f32 v127, v127
    v_cvt_pk_bf16_f32 v146, v124, v125
    v_cvt_pk_bf16_f32 v147, v126, v127
    s_waitcnt vmcnt(8)
    s_barrier
    s_add_u32 m0, s92, 32768
    v_mfma_f32_16x16x32_bf16 v[252:255], a[224:227], v[136:139], v[252:255]
    ds_read_b64_tr_b16 a[160:161], v5 offset:16896
    ds_read_b64_tr_b16 a[162:163], v5 offset:17408
    ds_read_b64_tr_b16 a[164:165], v5 offset:16928
    ds_read_b64_tr_b16 a[166:167], v5 offset:17440
    ds_read_b64_tr_b16 a[168:169], v5 offset:16960
    ds_read_b64_tr_b16 a[170:171], v5 offset:17472
    ds_read_b64_tr_b16 a[172:173], v5 offset:16992
    ds_read_b64_tr_b16 a[174:175], v5 offset:17504
    ds_read_b64_tr_b16 a[176:177], v6 offset:16896
    ds_read_b64_tr_b16 a[178:179], v6 offset:17408
    ds_read_b64_tr_b16 a[180:181], v6 offset:16928
    ds_read_b64_tr_b16 a[182:183], v6 offset:17440
    ds_read_b64_tr_b16 a[184:185], v6 offset:16960
    ds_read_b64_tr_b16 a[186:187], v6 offset:17472
    ds_read_b64_tr_b16 a[188:189], v6 offset:16992
    ds_read_b64_tr_b16 a[190:191], v6 offset:17504
    s_waitcnt lgkmcnt(14)
    v_mfma_f32_16x16x32_bf16 v[212:215], a[160:163], v[136:139], v[212:215]
    buffer_load_dwordx4 v11, s[36:39], s72 offen lds
    s_waitcnt lgkmcnt(12)
    v_mfma_f32_16x16x32_bf16 v[216:219], a[164:167], v[136:139], v[216:219]
    ds_read_b64_tr_b16 a[192:193], v7 offset:16896
    s_add_u32 s5, s72, 8192
    s_waitcnt lgkmcnt(11)
    v_mfma_f32_16x16x32_bf16 v[220:223], a[168:171], v[136:139], v[220:223]
    buffer_load_dwordx4 v11, s[36:39], s5 offen offset:1024 lds
    s_waitcnt lgkmcnt(9)
    v_mfma_f32_16x16x32_bf16 v[224:227], a[172:175], v[136:139], v[224:227]
    ds_read_b64_tr_b16 a[194:195], v7 offset:17408
    s_add_u32 s4, s72, 16384
    s_waitcnt lgkmcnt(2)
    v_mfma_f32_16x16x32_bf16 v[228:231], a[176:179], v[136:139], v[228:231]
    buffer_load_dwordx4 v11, s[36:39], s4 offen offset:2048 lds
    ds_read_b64_tr_b16 a[196:197], v7 offset:16928
    ds_read_b64_tr_b16 a[198:199], v7 offset:17440
    v_mfma_f32_16x16x32_bf16 v[232:235], a[180:183], v[136:139], v[232:235]
    ds_read_b64_tr_b16 a[200:201], v7 offset:16960
    ds_read_b64_tr_b16 a[202:203], v7 offset:17472
    s_add_u32 s5, s72, 24576
    v_mfma_f32_16x16x32_bf16 v[236:239], a[184:187], v[136:139], v[236:239]
    buffer_load_dwordx4 v11, s[36:39], s5 offen offset:3072 lds
    ds_write_b32 v19, v252 offset:4096
    v_mfma_f32_16x16x32_bf16 v[240:243], a[188:191], v[136:139], v[240:243]
    ds_write_b128 v19, v[228:231] offset:0
    s_add_u32 m0, s92, 36864
    s_add_u32 s4, s72, 36864
    v_mfma_f32_16x16x32_bf16 v[244:247], a[224:227], v[128:131], v[244:247]
    buffer_load_dwordx4 v11, s[36:39], s4 offen lds
    ds_write_b128 v19, v[232:235] offset:1024
    v_mfma_f32_16x16x32_bf16 v[148:151], a[160:163], v[128:131], v[148:151]
    ds_write_b128 v19, v[236:239] offset:2048
    s_add_u32 s5, s72, 45056
    v_mfma_f32_16x16x32_bf16 v[152:155], a[164:167], v[128:131], v[152:155]
    buffer_load_dwordx4 v11, s[36:39], s5 offen offset:1024 lds
    ds_write_b128 v19, v[240:243] offset:3072
    v_mfma_f32_16x16x32_bf16 v[156:159], a[168:171], v[128:131], v[156:159]
    ds_read_b64_tr_b16 a[204:205], v7 offset:16992
    ds_read_b64_tr_b16 a[206:207], v7 offset:17504
    s_add_u32 s4, s72, 53248
    v_mfma_f32_16x16x32_bf16 v[160:163], a[172:175], v[128:131], v[160:163]
    buffer_load_dwordx4 v11, s[36:39], s4 offen offset:2048 lds
    ds_read_b64_tr_b16 a[208:209], v8 offset:16896
    ds_read_b64_tr_b16 a[210:211], v8 offset:17408
    v_mfma_f32_16x16x32_bf16 v[164:167], a[176:179], v[128:131], v[164:167]
    ds_read_b64_tr_b16 a[212:213], v8 offset:16928
    ds_read_b64_tr_b16 a[214:215], v8 offset:17440
    s_add_u32 s5, s72, 61440
    v_mfma_f32_16x16x32_bf16 v[168:171], a[180:183], v[128:131], v[168:171]
    buffer_load_dwordx4 v11, s[36:39], s5 offen offset:3072 lds
    ds_read_b64_tr_b16 a[216:217], v8 offset:16960
    ds_read_b64_tr_b16 a[218:219], v8 offset:17472
    v_mfma_f32_16x16x32_bf16 v[172:175], a[184:187], v[128:131], v[172:175]
    ds_read_b64_tr_b16 a[220:221], v8 offset:16992
    ds_read_b64_tr_b16 a[222:223], v8 offset:17504
    v_mfma_f32_16x16x32_bf16 v[176:179], a[188:191], v[128:131], v[176:179]
    s_waitcnt vmcnt(8) lgkmcnt(6)
    s_barrier
    s_add_u32 m0, s92, 65536
    v_mfma_f32_16x16x32_bf16 v[244:247], a[224:227], v[140:143], v[244:247]
    ds_read_b32 v104, v20 offset:4096
    ds_read_b128 v[88:91], v20 offset:0
    ds_read_b128 v[92:95], v20 offset:1024
    ds_read_b128 v[96:99], v20 offset:2048
    ds_read_b128 v[100:103], v20 offset:3072
    v_mfma_f32_16x16x32_bf16 v[148:151], a[192:195], v[140:143], v[148:151]
    buffer_load_dwordx4 v11, s[36:39], s73 offen lds
    ds_read_b64_tr_b16 a[0:1], v12 offset:0
    ds_read_b64_tr_b16 a[2:3], v12 offset:2048
    s_add_u32 s5, s73, 8192
    v_mfma_f32_16x16x32_bf16 v[152:155], a[196:199], v[140:143], v[152:155]
    buffer_load_dwordx4 v11, s[36:39], s5 offen offset:1024 lds
    ds_read_b64_tr_b16 a[4:5], v12 offset:4096
    ds_read_b64_tr_b16 a[6:7], v12 offset:6144
    v_mfma_f32_16x16x32_bf16 v[156:159], a[200:203], v[140:143], v[156:159]
    ds_read_b64_tr_b16 a[8:9], v12 offset:8192
    ds_read_b64_tr_b16 a[10:11], v12 offset:10240
    s_add_u32 s4, s73, 16384
    v_rcp_f32 v245, v244
    v_mfma_f32_16x16x32_bf16 v[160:163], a[204:207], v[140:143], v[160:163]
    buffer_load_dwordx4 v11, s[36:39], s4 offen offset:2048 lds
    ds_read_b64_tr_b16 a[12:13], v12 offset:12288
    ds_read_b64_tr_b16 a[14:15], v12 offset:14336
    v_mul_f32 v148, v245, v148
    v_mul_f32 v149, v245, v149
    v_mul_f32 v150, v245, v150
    v_mul_f32 v151, v245, v151
    v_cvt_pk_bf16_f32 v108, v148, v149
    v_cvt_pk_bf16_f32 v109, v150, v151
    v_mfma_f32_16x16x32_bf16 v[164:167], a[208:211], v[140:143], v[164:167]
    ds_read_b64_tr_b16 a[16:17], v12 offset:16384
    ds_read_b64_tr_b16 a[18:19], v12 offset:18432
    s_add_u32 s5, s73, 24576
    v_mul_f32 v152, v245, v152
    v_mul_f32 v153, v245, v153
    v_mul_f32 v154, v245, v154
    v_mul_f32 v155, v245, v155
    v_cvt_pk_bf16_f32 v110, v152, v153
    v_cvt_pk_bf16_f32 v111, v154, v155
    s_waitcnt lgkmcnt(8)
    v_mfma_f32_16x16x32_bf16 v[168:171], a[212:215], v[140:143], v[168:171]
    ds_read_b64_tr_b16 a[20:21], v12 offset:20480
    ds_read_b64_tr_b16 a[22:23], v12 offset:22528
    s_add_u32 s4, s73, 36864
    v_add_f32 v104, v104, v252
    v_add_f32 v212, v212, v88
    v_add_f32 v213, v213, v89
    v_add_f32 v214, v214, v90
    v_add_f32 v215, v215, v91
    v_add_f32 v216, v216, v92
    v_add_f32 v217, v217, v93
    v_add_f32 v218, v218, v94
    v_add_f32 v219, v219, v95
    v_add_f32 v220, v220, v96
    v_add_f32 v221, v221, v97
    v_add_f32 v222, v222, v98
    v_add_f32 v223, v223, v99
    v_add_f32 v224, v224, v100
    v_add_f32 v225, v225, v101
    v_add_f32 v226, v226, v102
    v_add_f32 v227, v227, v103
    v_mul_f32 v156, v245, v156
    v_mul_f32 v157, v245, v157
    v_mul_f32 v158, v245, v158
    v_mul_f32 v159, v245, v159
    v_cvt_pk_bf16_f32 v112, v156, v157
    v_cvt_pk_bf16_f32 v113, v158, v159
    v_mfma_f32_16x16x32_bf16 v[172:175], a[216:219], v[140:143], v[172:175]
    buffer_load_dwordx4 v11, s[36:39], s5 offen offset:3072 lds
    ds_read_b64_tr_b16 a[24:25], v12 offset:24576
    ds_read_b64_tr_b16 a[26:27], v12 offset:26624
    s_add_u32 m0, s92, 69632
    v_rcp_f32 v253, v104
    v_mul_f32 v160, v245, v160
    v_mul_f32 v161, v245, v161
    v_mul_f32 v162, v245, v162
    v_mul_f32 v163, v245, v163
    v_cvt_pk_bf16_f32 v114, v160, v161
    v_cvt_pk_bf16_f32 v115, v162, v163
    v_mfma_f32_16x16x32_bf16 v[176:179], a[220:223], v[140:143], v[176:179]
    ds_read_b64_tr_b16 a[28:29], v12 offset:28672
    ds_read_b64_tr_b16 a[30:31], v12 offset:30720
    s_add_u32 s5, s73, 45056
    v_mul_f32 v212, v253, v212
    v_mul_f32 v213, v253, v213
    v_mul_f32 v214, v253, v214
    v_mul_f32 v215, v253, v215
    v_cvt_pk_bf16_f32 v128, v212, v213
    v_cvt_pk_bf16_f32 v129, v214, v215
    v_mul_f32 v216, v253, v216
    v_mul_f32 v217, v253, v217
    v_mul_f32 v218, v253, v218
    v_mul_f32 v219, v253, v219
    v_cvt_pk_bf16_f32 v130, v216, v217
    v_cvt_pk_bf16_f32 v131, v218, v219
    v_mul_f32 v220, v253, v220
    v_mul_f32 v221, v253, v221
    v_mul_f32 v222, v253, v222
    v_mul_f32 v223, v253, v223
    v_cvt_pk_bf16_f32 v137, v222, v223
    v_mul_f32 v224, v253, v224
    v_mul_f32 v225, v253, v225
    v_mul_f32 v226, v253, v226
    v_mul_f32 v227, v253, v227
    v_cvt_pk_bf16_f32 v138, v224, v225
    v_mul_f32 v164, v245, v164
    v_mul_f32 v165, v245, v165
    v_mul_f32 v166, v245, v166
    v_mul_f32 v167, v245, v167
    v_cvt_pk_bf16_f32 v116, v164, v165
    v_cvt_pk_bf16_f32 v117, v166, v167
    v_mfma_f32_16x16x32_bf16 v[248:251], a[224:227], v[132:135], v[248:251]
    buffer_load_dwordx4 v11, s[36:39], s4 offen lds
    ds_write_b128 v15, v[108:111] offset:28736
    v_cvt_pk_bf16_f32 v136, v220, v221
    v_cvt_pk_bf16_f32 v139, v226, v227
    v_mul_f32 v168, v245, v168
    v_mul_f32 v169, v245, v169
    v_mul_f32 v170, v245, v170
    v_mul_f32 v171, v245, v171
    v_cvt_pk_bf16_f32 v118, v168, v169
    v_cvt_pk_bf16_f32 v119, v170, v171
    v_mfma_f32_16x16x32_bf16 v[180:183], a[160:163], v[132:135], v[180:183]
    buffer_load_dwordx4 v11, s[36:39], s5 offen offset:1024 lds
    ds_write_b128 v17, v[128:131] offset:20544
    v_mul_f32 v173, v245, v173
    v_mul_f32 v174, v245, v174
    v_mul_f32 v175, v245, v175
    v_cvt_pk_bf16_f32 v229, v174, v175
    v_mfma_f32_16x16x32_bf16 v[184:187], a[164:167], v[132:135], v[184:187]
    ds_write_b128 v17, v[136:139] offset:21568
    v_mul_f32 v172, v245, v172
    v_mul_f32 v176, v245, v176
    v_mul_f32 v177, v245, v177
    v_mul_f32 v179, v245, v179
    v_cvt_pk_bf16_f32 v230, v176, v177
    v_mfma_f32_16x16x32_bf16 v[188:191], a[168:171], v[132:135], v[188:191]
    ds_write_b128 v15, v[112:115] offset:29760
    s_add_u32 s4, s73, 53248
    v_cvt_pk_bf16_f32 v228, v172, v173
    v_mul_f32 v178, v245, v178
    v_cvt_pk_bf16_f32 v231, v178, v179
    v_mfma_f32_16x16x32_bf16 v[192:195], a[172:175], v[132:135], v[192:195]
    buffer_load_dwordx4 v11, s[36:39], s4 offen offset:2048 lds
    ds_write_b128 v16, v[116:119] offset:28736
    v_mfma_f32_16x16x32_bf16 v[196:199], a[176:179], v[132:135], v[196:199]
    ds_write_b128 v16, v[228:231] offset:29760
    s_add_u32 s5, s73, 61440
    v_mfma_f32_16x16x32_bf16 v[200:203], a[180:183], v[132:135], v[200:203]
    buffer_load_dwordx4 v11, s[36:39], s5 offen offset:3072 lds
    v_mfma_f32_16x16x32_bf16 v[204:207], a[184:187], v[132:135], v[204:207]
    v_mfma_f32_16x16x32_bf16 v[208:211], a[188:191], v[132:135], v[208:211]
    s_waitcnt vmcnt(8) lgkmcnt(0)
    s_barrier
    s_add_u32 m0, s92, 0
    v_mfma_f32_16x16x32_bf16 v[248:251], a[224:227], v[144:147], v[248:251]
    ds_read_b128 a[96:99], v18 offset:20544
    ds_read_b128 a[100:103], v18 offset:21568
    ds_read_b128 a[112:115], v18 offset:24640
    ds_read_b128 a[116:119], v18 offset:25664
    ds_read_b64_tr_b16 a[54:55], v12 offset:55296
    ds_read_b64_tr_b16 a[56:57], v12 offset:57344
    v_mfma_f32_16x16x32_bf16 v[180:183], a[192:195], v[144:147], v[180:183]
    ds_read_b128 a[104:107], v18 offset:22592
    ds_read_b128 a[120:123], v18 offset:26688
    ds_read_b64_tr_b16 a[58:59], v12 offset:59392
    ds_read_b64_tr_b16 a[60:61], v12 offset:61440
    v_mfma_f32_16x16x32_bf16 v[184:187], a[196:199], v[144:147], v[184:187]
    ds_read_b128 a[108:111], v18 offset:23616
    ds_read_b128 a[124:127], v18 offset:27712
    ds_read_b64_tr_b16 a[62:63], v12 offset:63488
    ds_read_b128 a[128:131], v18 offset:28736
    v_mfma_f32_16x16x32_bf16 v[188:191], a[200:203], v[144:147], v[188:191]
    ds_read_b64_tr_b16 a[32:33], v12 offset:32768
    ds_read_b128 a[132:135], v18 offset:29760
    ds_read_b128 a[136:139], v18 offset:30784
    v_rcp_f32 v249, v248
    v_max3_f32 v105, v244, v248, v104
    v_mfma_f32_16x16x32_bf16 v[192:195], a[204:207], v[144:147], v[192:195]
    buffer_load_dwordx4 v11, s[36:39], s74 offen lds
    ds_read_b64_tr_b16 a[34:35], v12 offset:34816
    ds_read_b128 a[140:143], v18 offset:31808
    v_cmp_lt_f32 vcc, 0x4e800000, v105
    v_mul_f32 v183, v249, v183
    v_mfma_f32_16x16x32_bf16 v[196:199], a[208:211], v[144:147], v[196:199]
    ds_read_b64_tr_b16 a[36:37], v12 offset:36864
    s_mov_b64 s[6:7], vcc
    v_min3_f32 v105, v244, v248, v104
    v_cmp_gt_f32 vcc, 0x30800000, v105
    v_mul_f32 v186, v249, v186
    v_mfma_f32_16x16x32_bf16 v[200:203], a[212:215], v[144:147], v[200:203]
    ds_read_b64_tr_b16 a[38:39], v12 offset:38912
    ds_read_b128 a[144:147], v18 offset:32832
    v_mul_f32 v187, v249, v187
    v_mfma_f32_16x16x32_bf16 v[204:207], a[216:219], v[144:147], v[204:207]
    ds_read_b64_tr_b16 a[40:41], v12 offset:40960
    ds_read_b128 a[148:151], v18 offset:33856
    ds_read_b128 a[152:155], v18 offset:34880
    s_add_u32 s5, s74, 8192
    v_mfma_f32_16x16x32_bf16 v[208:211], a[220:223], v[144:147], v[208:211]
    buffer_load_dwordx4 v11, s[36:39], s5 offen offset:1024 lds
    ds_read_b64_tr_b16 a[42:43], v12 offset:43008
    v_mul_f32 v188, v249, v188
    v_mul_f32 v189, v249, v189
    s_waitcnt lgkmcnt(7)
    v_mfma_f32_16x16x32_bf16 v[148:151], a[0:3], a[96:99], 0
    ds_read_b64_tr_b16 a[44:45], v12 offset:45056
    ds_read_b128 a[156:159], v18 offset:35904
    v_mul_f32 v190, v249, v190
    v_mfma_f32_16x16x32_bf16 v[148:151], a[4:7], a[100:103], v[148:151]
    ds_read_b64_tr_b16 a[46:47], v12 offset:47104
    s_add_u32 s4, s74, 16384
    v_mul_f32 v191, v249, v191
    v_mul_f32 v192, v249, v192
    v_mfma_f32_16x16x32_bf16 v[148:151], a[8:11], a[104:107], v[148:151]
    buffer_load_dwordx4 v11, s[36:39], s4 offen offset:2048 lds
    v_mul_f32 v193, v249, v193
    v_mul_f32 v194, v249, v194
    v_mfma_f32_16x16x32_bf16 v[148:151], a[12:15], a[108:111], v[148:151]
    ds_read_b64_tr_b16 a[48:49], v12 offset:49152
    v_mul_f32 v195, v249, v195
    v_mul_f32 v196, v249, v196
    v_mfma_f32_16x16x32_bf16 v[148:151], a[16:19], a[112:115], v[148:151]
    ds_read_b64_tr_b16 a[50:51], v12 offset:51200
    v_mul_f32 v197, v249, v197
    v_mul_f32 v198, v249, v198
    v_mfma_f32_16x16x32_bf16 v[148:151], a[20:23], a[116:119], v[148:151]
    ds_read_b64_tr_b16 a[52:53], v12 offset:53248
    v_mul_f32 v199, v249, v199
    v_mul_f32 v200, v249, v200
    v_mfma_f32_16x16x32_bf16 v[148:151], a[24:27], a[120:123], v[148:151]
    s_add_u32 s5, s74, 24576
    v_mul_f32 v180, v249, v180
    v_mul_f32 v201, v249, v201
    v_mul_f32 v202, v249, v202
    v_mfma_f32_16x16x32_bf16 v[148:151], a[28:31], a[124:127], v[148:151]
    buffer_load_dwordx4 v11, s[36:39], s5 offen offset:3072 lds
    v_mul_f32 v181, v249, v181
    v_mul_f32 v203, v249, v203
    v_mul_f32 v204, v249, v204
    v_mfma_f32_16x16x32_bf16 v[152:155], a[32:35], a[96:99], 0
    s_add_u32 m0, s92, 4096
    v_mul_f32 v182, v249, v182
    v_mul_f32 v205, v249, v205
    v_mul_f32 v206, v249, v206
    s_waitcnt lgkmcnt(1)
    v_mfma_f32_16x16x32_bf16 v[152:155], a[36:39], a[100:103], v[152:155]
    s_add_u32 s4, s74, 36864
    v_cvt_pk_bf16_f32 v120, v180, v181
    v_mul_f32 v184, v249, v184
    v_mul_f32 v207, v249, v207
    v_mfma_f32_16x16x32_bf16 v[152:155], a[40:43], a[104:107], v[152:155]
    s_or_b64 s[6:7], s[6:7], vcc
    v_cvt_pk_bf16_f32 v121, v182, v183
    v_mul_f32 v185, v249, v185
    v_cvt_pk_bf16_f32 v122, v184, v185
    v_mfma_f32_16x16x32_bf16 v[152:155], a[44:47], a[108:111], v[152:155]
    buffer_load_dwordx4 v11, s[36:39], s4 offen lds
    v_cvt_pk_bf16_f32 v123, v186, v187
    v_mul_f32 v208, v249, v208
    v_mfma_f32_16x16x32_bf16 v[152:155], a[48:51], a[112:115], v[152:155]
    s_or_b32 s6, s6, s7
    v_mul_f32 v209, v249, v209
    v_mul_f32 v210, v249, v210
    s_waitcnt lgkmcnt(0)
    v_mfma_f32_16x16x32_bf16 v[152:155], a[52:55], a[116:119], v[152:155]
    s_add_u32 s5, s74, 45056
    v_mov_b32 v105, s6
    v_mul_f32 v211, v249, v211
    v_mfma_f32_16x16x32_bf16 v[152:155], a[56:59], a[120:123], v[152:155]
    ds_read_b128 a[160:163], v18 offset:36928
    v_cvt_pk_bf16_f32 v124, v188, v189
    v_mfma_f32_16x16x32_bf16 v[152:155], a[60:63], a[124:127], v[152:155]
    buffer_load_dwordx4 v11, s[36:39], s5 offen offset:1024 lds
    v_cvt_pk_bf16_f32 v125, v190, v191
    v_cvt_pk_bf16_f32 v126, v192, v193
    v_mfma_f32_16x16x32_bf16 v[156:159], a[0:3], a[128:131], 0
    ds_read_b128 a[164:167], v18 offset:37952
    v_cvt_pk_bf16_f32 v127, v194, v195
    v_mfma_f32_16x16x32_bf16 v[156:159], a[4:7], a[132:135], v[156:159]
    s_add_u32 s4, s74, 53248
    v_cvt_pk_bf16_f32 v88, v196, v197
    v_cvt_pk_bf16_f32 v89, v198, v199
    v_cvt_pk_bf16_f32 v212, v148, v149
    v_mfma_f32_16x16x32_bf16 v[156:159], a[8:11], a[136:139], v[156:159]
    s_add_u32 s5, s74, 61440
    v_cvt_pk_bf16_f32 v90, v200, v201
    v_cvt_pk_bf16_f32 v91, v202, v203
    v_cvt_pk_bf16_f32 v213, v150, v151
    v_mfma_f32_16x16x32_bf16 v[156:159], a[12:15], a[140:143], v[156:159]
    buffer_load_dwordx4 v11, s[36:39], s4 offen offset:2048 lds
    ds_read_b128 a[168:171], v18 offset:38976
    ds_read_b128 a[172:175], v18 offset:40000
    v_cvt_pk_bf16_f32 v214, v152, v153
    v_mfma_f32_16x16x32_bf16 v[156:159], a[16:19], a[144:147], v[156:159]
    ds_read_b128 a[176:179], v18 offset:41024
    ds_read_b128 a[180:183], v18 offset:42048
    v_cvt_pk_bf16_f32 v215, v154, v155
    v_mfma_f32_16x16x32_bf16 v[156:159], a[20:23], a[148:151], v[156:159]
    ds_read_b128 a[184:187], v18 offset:43072
    ds_read_b128 a[188:191], v18 offset:44096
    v_mfma_f32_16x16x32_bf16 v[156:159], a[24:27], a[152:155], v[156:159]
    buffer_store_dwordx4 v[212:215], v21, s[40:43], s10 offen sc1
    v_cvt_pk_bf16_f32 v92, v204, v205
    v_cvt_pk_bf16_f32 v93, v206, v207
    v_mfma_f32_16x16x32_bf16 v[156:159], a[28:31], a[156:159], v[156:159]
    buffer_load_dwordx4 v11, s[36:39], s5 offen offset:3072 lds
    v_cvt_pk_bf16_f32 v94, v208, v209
    v_cvt_pk_bf16_f32 v95, v210, v211
    v_mfma_f32_16x16x32_bf16 v[160:163], a[32:35], a[128:131], 0
    ds_write_b128 v15, v[120:123] offset:0
    v_mfma_f32_16x16x32_bf16 v[160:163], a[36:39], a[132:135], v[160:163]
    ds_write_b32 v23, v105 offset:0
    v_mfma_f32_16x16x32_bf16 v[160:163], a[40:43], a[136:139], v[160:163]
    ds_write_b128 v15, v[124:127] offset:1024
    v_mfma_f32_16x16x32_bf16 v[160:163], a[44:47], a[140:143], v[160:163]
    ds_write_b128 v16, v[88:91] offset:0
    v_mfma_f32_16x16x32_bf16 v[160:163], a[48:51], a[144:147], v[160:163]
    ds_write_b128 v16, v[92:95] offset:1024
    v_mfma_f32_16x16x32_bf16 v[160:163], a[52:55], a[148:151], v[160:163]
    s_add_u32 s10, s47, 16384
    v_cvt_pk_bf16_f32 v216, v156, v157
    v_cvt_pk_bf16_f32 v217, v158, v159
    v_mfma_f32_16x16x32_bf16 v[160:163], a[56:59], a[152:155], v[160:163]
    v_mfma_f32_16x16x32_bf16 v[160:163], a[60:63], a[156:159], v[160:163]
    s_waitcnt vmcnt(9) lgkmcnt(0)
    s_barrier
    s_add_u32 m0, s92, 32768
    v_mfma_f32_16x16x32_bf16 v[164:167], a[0:3], a[160:163], 0
    ds_read_b128 a[192:195], v18 offset:0
    s_add_u32 s5, s75, 8192
    v_mfma_f32_16x16x32_bf16 v[164:167], a[4:7], a[164:167], v[164:167]
    buffer_load_dwordx4 v11, s[36:39], s75 offen lds
    v_mfma_f32_16x16x32_bf16 v[164:167], a[8:11], a[168:171], v[164:167]
    s_add_u32 s4, s75, 16384
    v_cvt_pk_bf16_f32 v218, v160, v161
    v_cvt_pk_bf16_f32 v219, v162, v163
    v_mfma_f32_16x16x32_bf16 v[164:167], a[12:15], a[172:175], v[164:167]
    buffer_store_dwordx4 v[216:219], v21, s[40:43], s11 offen sc1
    v_mfma_f32_16x16x32_bf16 v[164:167], a[16:19], a[176:179], v[164:167]
    ds_read_b128 a[196:199], v18 offset:1024
    s_add_u32 s11, s47, 20480
    v_mfma_f32_16x16x32_bf16 v[164:167], a[20:23], a[180:183], v[164:167]
    ds_read_b128 a[200:203], v18 offset:2048
    v_mfma_f32_16x16x32_bf16 v[164:167], a[24:27], a[184:187], v[164:167]
    buffer_load_dwordx4 v11, s[36:39], s5 offen offset:1024 lds
    v_mfma_f32_16x16x32_bf16 v[164:167], a[28:31], a[188:191], v[164:167]
    ds_read_b128 a[204:207], v18 offset:3072
    s_add_u32 s5, s75, 24576
    v_mfma_f32_16x16x32_bf16 v[168:171], a[32:35], a[160:163], 0
    ds_read_b128 a[208:211], v18 offset:4096
    v_mfma_f32_16x16x32_bf16 v[168:171], a[36:39], a[164:167], v[168:171]
    ds_read_b128 a[212:215], v18 offset:5120
    v_mfma_f32_16x16x32_bf16 v[168:171], a[40:43], a[168:171], v[168:171]
    ds_read_b128 a[216:219], v18 offset:6144
    v_cvt_pk_bf16_f32 v220, v164, v165
    v_mfma_f32_16x16x32_bf16 v[168:171], a[44:47], a[172:175], v[168:171]
    ds_read_b128 a[220:223], v18 offset:7168
    v_cvt_pk_bf16_f32 v221, v166, v167
    v_mfma_f32_16x16x32_bf16 v[168:171], a[48:51], a[176:179], v[168:171]
    buffer_load_dwordx4 v11, s[36:39], s4 offen offset:2048 lds
    v_mfma_f32_16x16x32_bf16 v[168:171], a[52:55], a[180:183], v[168:171]
    ds_read_b128 a[224:227], v18 offset:8192
    s_add_u32 s4, s75, 36864
    v_mfma_f32_16x16x32_bf16 v[168:171], a[56:59], a[184:187], v[168:171]
    ds_read_b128 a[228:231], v18 offset:9216
    v_mfma_f32_16x16x32_bf16 v[168:171], a[60:63], a[188:191], v[168:171]
    ds_read_b128 a[232:235], v18 offset:10240
    s_waitcnt lgkmcnt(3)
    v_mfma_f32_16x16x32_bf16 v[172:175], a[0:3], a[192:195], 0
    buffer_load_dwordx4 v11, s[36:39], s5 offen offset:3072 lds
    v_mfma_f32_16x16x32_bf16 v[172:175], a[4:7], a[196:199], v[172:175]
    ds_read_b128 a[236:239], v18 offset:11264
    s_add_u32 m0, s92, 36864
    v_mfma_f32_16x16x32_bf16 v[172:175], a[8:11], a[200:203], v[172:175]
    s_add_u32 s5, s75, 45056
    v_cvt_pk_bf16_f32 v222, v168, v169
    v_cvt_pk_bf16_f32 v223, v170, v171
    v_mfma_f32_16x16x32_bf16 v[172:175], a[12:15], a[204:207], v[172:175]
    buffer_store_dwordx4 v[220:223], v21, s[40:43], s10 offen sc1
    v_mfma_f32_16x16x32_bf16 v[172:175], a[16:19], a[208:211], v[172:175]
    ds_read_b128 a[240:243], v18 offset:12288
    s_add_u32 s10, s47, 32768
    v_mfma_f32_16x16x32_bf16 v[172:175], a[20:23], a[212:215], v[172:175]
    buffer_load_dwordx4 v11, s[36:39], s4 offen lds
    v_mfma_f32_16x16x32_bf16 v[172:175], a[24:27], a[216:219], v[172:175]
    ds_read_b128 a[244:247], v18 offset:13312
    s_add_u32 s4, s75, 53248
    v_mfma_f32_16x16x32_bf16 v[172:175], a[28:31], a[220:223], v[172:175]
    ds_read_b128 a[248:251], v18 offset:14336
    v_mfma_f32_16x16x32_bf16 v[176:179], a[32:35], a[192:195], 0
    ds_read_b128 a[252:255], v18 offset:15360
    v_mfma_f32_16x16x32_bf16 v[176:179], a[36:39], a[196:199], v[176:179]
    ds_read_b128 v[100:103], v14 offset:0
    v_mfma_f32_16x16x32_bf16 v[176:179], a[40:43], a[200:203], v[176:179]
    s_nop 0
    s_nop 0
    v_cvt_pk_bf16_f32 v224, v172, v173
    v_cvt_pk_bf16_f32 v225, v174, v175
    v_mfma_f32_16x16x32_bf16 v[176:179], a[44:47], a[204:207], v[176:179]
    buffer_load_dwordx4 v11, s[36:39], s5 offen offset:1024 lds
    v_mfma_f32_16x16x32_bf16 v[176:179], a[48:51], a[208:211], v[176:179]
    ds_read_b64_tr_b16 a[64:65], v13 offset:0
    s_add_u32 s5, s75, 61440
    v_mfma_f32_16x16x32_bf16 v[176:179], a[52:55], a[212:215], v[176:179]
    ds_read_b64_tr_b16 a[66:67], v13 offset:2048
    v_mfma_f32_16x16x32_bf16 v[176:179], a[56:59], a[216:219], v[176:179]
    ds_read_b64_tr_b16 a[68:69], v13 offset:4096
    v_mfma_f32_16x16x32_bf16 v[176:179], a[60:63], a[220:223], v[176:179]
    ds_read_b64_tr_b16 a[70:71], v13 offset:6144
    s_waitcnt lgkmcnt(4)
    v_or3_b32 v100, v100, v101, v102
    v_mfma_f32_16x16x32_bf16 v[180:183], a[0:3], a[224:227], 0
    buffer_load_dwordx4 v11, s[36:39], s4 offen offset:2048 lds
    v_mfma_f32_16x16x32_bf16 v[180:183], a[4:7], a[228:231], v[180:183]
    ds_read_b64_tr_b16 a[72:73], v13 offset:8192
    v_or_b32 v100, v100, v103
    v_mfma_f32_16x16x32_bf16 v[180:183], a[8:11], a[232:235], v[180:183]
    v_cvt_pk_bf16_f32 v226, v176, v177
    v_cvt_pk_bf16_f32 v227, v178, v179
    v_mfma_f32_16x16x32_bf16 v[180:183], a[12:15], a[236:239], v[180:183]
    buffer_store_dwordx4 v[224:227], v21, s[40:43], s11 offen sc1
    v_mfma_f32_16x16x32_bf16 v[180:183], a[16:19], a[240:243], v[180:183]
    buffer_load_dwordx4 v11, s[36:39], s5 offen offset:3072 lds
    v_mfma_f32_16x16x32_bf16 v[180:183], a[20:23], a[244:247], v[180:183]
    ds_read_b64_tr_b16 a[74:75], v13 offset:10240
    v_readfirstlane_b32 s8, v100
    v_mfma_f32_16x16x32_bf16 v[180:183], a[24:27], a[248:251], v[180:183]
    ds_read_b64_tr_b16 a[76:77], v13 offset:12288
    s_add_u32 s11, s47, 36864
    v_mfma_f32_16x16x32_bf16 v[180:183], a[28:31], a[252:255], v[180:183]
    ds_read_b64_tr_b16 a[78:79], v13 offset:14336
    v_mfma_f32_16x16x32_bf16 v[184:187], a[32:35], a[224:227], 0
    ds_read_b64_tr_b16 a[80:81], v13 offset:16384
    ds_read_b64_tr_b16 a[82:83], v13 offset:18432
    v_mfma_f32_16x16x32_bf16 v[184:187], a[36:39], a[228:231], v[184:187]
    ds_read_b64_tr_b16 a[84:85], v13 offset:20480
    ds_read_b64_tr_b16 a[86:87], v13 offset:22528
    v_mfma_f32_16x16x32_bf16 v[184:187], a[40:43], a[232:235], v[184:187]
    ds_read_b64_tr_b16 a[88:89], v13 offset:24576
    v_cvt_pk_bf16_f32 v228, v180, v181
    v_mfma_f32_16x16x32_bf16 v[184:187], a[44:47], a[236:239], v[184:187]
    ds_read_b64_tr_b16 a[90:91], v13 offset:26624
    ds_read_b64_tr_b16 a[92:93], v13 offset:28672
    v_mfma_f32_16x16x32_bf16 v[184:187], a[48:51], a[240:243], v[184:187]
    ds_read_b64_tr_b16 a[94:95], v13 offset:30720
    v_cvt_pk_bf16_f32 v229, v182, v183
    v_mfma_f32_16x16x32_bf16 v[184:187], a[52:55], a[244:247], v[184:187]
    v_mfma_f32_16x16x32_bf16 v[184:187], a[56:59], a[248:251], v[184:187]
    v_mfma_f32_16x16x32_bf16 v[184:187], a[60:63], a[252:255], v[184:187]
    s_andn2_b32 s8, s8, s94
    s_cbranch_scc1 L_fallback
    s_bfe_u32 s49, s45, 0x30001
    s_waitcnt vmcnt(11) lgkmcnt(0)
    s_barrier
    s_add_u32 m0, s92, 65536
    v_mfma_f32_16x16x32_bf16 v[188:191], a[64:67], a[128:131], 0
    ds_read_b64_tr_b16 a[0:1], v12 offset:0
    s_nop 0
    v_cvt_pk_bf16_f32 v230, v184, v185
    v_mfma_f32_16x16x32_bf16 v[188:191], a[68:71], a[132:135], v[188:191]
    s_add_u32 s5, s76, 8192
    v_cvt_pk_bf16_f32 v231, v186, v187
    v_and_b32 v60, 63, v0
    v_mfma_f32_16x16x32_bf16 v[188:191], a[72:75], a[136:139], v[188:191]
    buffer_load_dwordx4 v11, s[36:39], s76 offen lds
    v_mfma_f32_16x16x32_bf16 v[188:191], a[76:79], a[140:143], v[188:191]
    buffer_store_dwordx4 v[228:231], v21, s[40:43], s10 offen sc1
    v_mfma_f32_16x16x32_bf16 v[188:191], a[80:83], a[144:147], v[188:191]
    s_add_u32 s4, s76, 16384
    v_min_u32 v60, 1, v60
    v_lshlrev_b32 v59, 28, v60
    v_mfma_f32_16x16x32_bf16 v[188:191], a[84:87], a[148:151], v[188:191]
    buffer_load_dwordx4 v11, s[36:39], s5 offen offset:1024 lds
    v_mfma_f32_16x16x32_bf16 v[188:191], a[88:91], a[152:155], v[188:191]
    ds_read_b64_tr_b16 a[2:3], v12 offset:2048
    v_mov_b32 v41, 1
    v_mfma_f32_16x16x32_bf16 v[188:191], a[92:95], a[156:159], v[188:191]
    ds_read_b64_tr_b16 a[4:5], v12 offset:4096
    v_and_b32 v61, 1, v0
    v_mfma_f32_16x16x32_bf16 v[192:195], a[64:67], a[192:195], 0
    ds_read_b64_tr_b16 a[6:7], v12 offset:6144
    v_bfe_u32 v60, v0, 1, 3
    v_mfma_f32_16x16x32_bf16 v[192:195], a[68:71], a[196:199], v[192:195]
    ds_read_b64_tr_b16 a[8:9], v12 offset:8192
    v_lshlrev_b32 v61, 4, v61
    v_mfma_f32_16x16x32_bf16 v[192:195], a[72:75], a[200:203], v[192:195]
    buffer_load_dwordx4 v11, s[36:39], s4 offen offset:2048 lds
    v_mfma_f32_16x16x32_bf16 v[192:195], a[76:79], a[204:207], v[192:195]
    s_add_u32 s5, s76, 24576
    v_cvt_pk_bf16_f32 v232, v188, v189
    v_cvt_pk_bf16_f32 v233, v190, v191
    v_mfma_f32_16x16x32_bf16 v[192:195], a[80:83], a[208:211], v[192:195]
    ds_read_b64_tr_b16 a[10:11], v12 offset:10240
    v_mov_b32 v63, 0x3f80
    v_mfma_f32_16x16x32_bf16 v[192:195], a[84:87], a[212:215], v[192:195]
    ds_read_b64_tr_b16 a[12:13], v12 offset:12288
    v_lshlrev_b32 v61, v61, v63
    v_mfma_f32_16x16x32_bf16 v[192:195], a[88:91], a[216:219], v[192:195]
    buffer_load_dwordx4 v11, s[36:39], s5 offen offset:3072 lds
    v_mfma_f32_16x16x32_bf16 v[192:195], a[92:95], a[220:223], v[192:195]
    ds_read_b64_tr_b16 a[14:15], v12 offset:14336
    v_cmp_eq_u32 vcc, 0, v60
    v_mfma_f32_16x16x32_bf16 v[196:199], a[64:67], a[96:99], 0
    ds_read_b64_tr_b16 a[16:17], v12 offset:16384
    v_cndmask_b32 v28, 0, v61, vcc
    v_mfma_f32_16x16x32_bf16 v[196:199], a[68:71], a[100:103], v[196:199]
    s_add_u32 m0, s92, 69632
    s_add_u32 s4, s76, 36864
    v_cmp_eq_u32 vcc, 1, v60
    s_nop 1
    v_cndmask_b32 v29, 0, v61, vcc
    v_mfma_f32_16x16x32_bf16 v[196:199], a[72:75], a[104:107], v[196:199]
    buffer_load_dwordx4 v11, s[36:39], s4 offen lds
    v_mfma_f32_16x16x32_bf16 v[196:199], a[76:79], a[108:111], v[196:199]
    s_add_u32 s5, s76, 45056
    v_cvt_pk_bf16_f32 v234, v192, v193
    v_cvt_pk_bf16_f32 v235, v194, v195
    v_mfma_f32_16x16x32_bf16 v[196:199], a[80:83], a[112:115], v[196:199]
    buffer_store_dwordx4 v[232:235], v21, s[40:43], s11 offen sc1
    v_mfma_f32_16x16x32_bf16 v[196:199], a[84:87], a[116:119], v[196:199]
    ds_read_b64_tr_b16 a[18:19], v12 offset:18432
    v_cmp_eq_u32 vcc, 2, v60
    v_mfma_f32_16x16x32_bf16 v[196:199], a[88:91], a[120:123], v[196:199]
    buffer_load_dwordx4 v11, s[36:39], s5 offen offset:1024 lds
    v_mfma_f32_16x16x32_bf16 v[196:199], a[92:95], a[124:127], v[196:199]
    ds_read_b64_tr_b16 a[20:21], v12 offset:20480
    v_cndmask_b32 v30, 0, v61, vcc
    v_mfma_f32_16x16x32_bf16 v[200:203], a[64:67], a[160:163], 0
    ds_read_b64_tr_b16 a[22:23], v12 offset:22528
    v_cmp_eq_u32 vcc, 3, v60
    v_mfma_f32_16x16x32_bf16 v[200:203], a[68:71], a[164:167], v[200:203]
    s_add_u32 s4, s76, 53248
    v_cndmask_b32 v31, 0, v61, vcc
    v_cmp_eq_u32 vcc, 4, v60
    v_mfma_f32_16x16x32_bf16 v[200:203], a[72:75], a[168:171], v[200:203]
    buffer_load_dwordx4 v11, s[36:39], s4 offen offset:2048 lds
    v_mfma_f32_16x16x32_bf16 v[200:203], a[76:79], a[172:175], v[200:203]
    ds_read_b64_tr_b16 a[24:25], v12 offset:24576
    v_cvt_pk_bf16_f32 v236, v196, v197
    v_mfma_f32_16x16x32_bf16 v[200:203], a[80:83], a[176:179], v[200:203]
    ds_read_b64_tr_b16 a[26:27], v12 offset:26624
    v_cvt_pk_bf16_f32 v237, v198, v199
    v_mfma_f32_16x16x32_bf16 v[200:203], a[84:87], a[180:183], v[200:203]
    s_add_u32 s5, s76, 61440
    v_cndmask_b32 v32, 0, v61, vcc
    v_cmp_eq_u32 vcc, 5, v60
    v_mfma_f32_16x16x32_bf16 v[200:203], a[88:91], a[184:187], v[200:203]
    buffer_load_dwordx4 v11, s[36:39], s5 offen offset:3072 lds
    v_mfma_f32_16x16x32_bf16 v[200:203], a[92:95], a[188:191], v[200:203]
    s_lshl_b32 s49, s49, 10
    s_add_u32 s49, s49, 114688
    s_lshl_b32 s50, s3, 8
    s_add_u32 s50, s50, s49
    s_add_u32 s65, s47, s50
    s_waitcnt vmcnt(8) lgkmcnt(1)
    buffer_store_dword v41, v59, s[40:43], s65 offen offset:128 sc1
    s_add_u32 s10, s47, 49152
    v_mfma_f32_16x16x32_bf16 v[204:207], a[64:67], a[224:227], 0
    ds_read_b64_tr_b16 a[28:29], v12 offset:28672
    ds_read_b64_tr_b16 a[30:31], v12 offset:30720
    v_mfma_f32_16x16x32_bf16 v[204:207], a[68:71], a[228:231], v[204:207]
    s_add_u32 s11, s47, 53248
    v_cvt_pk_bf16_f32 v238, v200, v201
    v_cvt_pk_bf16_f32 v239, v202, v203
    v_mfma_f32_16x16x32_bf16 v[204:207], a[72:75], a[232:235], v[204:207]
    buffer_store_dwordx4 v[236:239], v21, s[40:43], s10 offen sc1
    v_mfma_f32_16x16x32_bf16 v[204:207], a[76:79], a[236:239], v[204:207]
    s_add_u32 s64, s93, s50
    v_cndmask_b32 v33, 0, v61, vcc
    v_mov_b32 v41, 2
    v_mfma_f32_16x16x32_bf16 v[204:207], a[80:83], a[240:243], v[204:207]
    s_add_u32 s61, s64, 128
    v_cmp_eq_u32 vcc, 6, v60
    s_nop 1
    v_cndmask_b32 v34, 0, v61, vcc
    v_mfma_f32_16x16x32_bf16 v[204:207], a[84:87], a[244:247], v[204:207]
    s_add_u32 s10, s47, 65536
    v_cmp_eq_u32 vcc, 7, v60
    s_nop 1
    v_cndmask_b32 v35, 0, v61, vcc
    v_mfma_f32_16x16x32_bf16 v[204:207], a[88:91], a[248:251], v[204:207]
    s_add_u32 s6, s93, 0
    v_lshrrev_b32 v61, 4, v0
    v_min_u32 v61, 1, v61
    v_mfma_f32_16x16x32_bf16 v[204:207], a[92:95], a[252:255], v[204:207]
    s_waitcnt lgkmcnt(0)
    s_barrier
    s_add_u32 m0, s92, 98304
    v_mfma_f32_16x16x32_bf16 v[208:211], a[0:3], a[128:131], 0
    ds_read_b64_tr_b16 a[32:33], v12 offset:32768
    v_lshlrev_b32 v61, 28, v61
    v_mfma_f32_16x16x32_bf16 v[208:211], a[4:7], a[132:135], v[208:211]
    s_add_u32 s5, s77, 8192
    v_cvt_pk_bf16_f32 v240, v204, v205
    v_cvt_pk_bf16_f32 v241, v206, v207
    v_mfma_f32_16x16x32_bf16 v[208:211], a[8:11], a[136:139], v[208:211]
    buffer_load_dwordx4 v11, s[36:39], s77 offen lds
    v_mfma_f32_16x16x32_bf16 v[208:211], a[12:15], a[140:143], v[208:211]
    ds_read_b64_tr_b16 a[34:35], v12 offset:34816
    v_bfe_u32 v60, v0, 1, 3
    v_mfma_f32_16x16x32_bf16 v[208:211], a[16:19], a[144:147], v[208:211]
    ds_read_b64_tr_b16 a[36:37], v12 offset:36864
    v_lshl_add_u32 v61, v60, 10, v61
    v_mfma_f32_16x16x32_bf16 v[208:211], a[20:23], a[148:151], v[208:211]
    ds_read_b64_tr_b16 a[38:39], v12 offset:38912
    v_lshl_add_u32 v61, v0, 17, v61
    v_mfma_f32_16x16x32_bf16 v[208:211], a[24:27], a[152:155], v[208:211]
    buffer_load_dwordx4 v11, s[36:39], s5 offen offset:1024 lds
    v_mfma_f32_16x16x32_bf16 v[208:211], a[28:31], a[156:159], v[208:211]
    ds_read_b64_tr_b16 a[40:41], v12 offset:40960
    v_bfe_u32 v60, s0, v0, 1
    v_mfma_f32_16x16x32_bf16 v[148:151], a[0:3], a[192:195], 0
    ds_read_b64_tr_b16 a[42:43], v12 offset:43008
    v_lshl_add_u32 v36, v60, 13, v61
    v_mfma_f32_16x16x32_bf16 v[148:151], a[4:7], a[196:199], v[148:151]
    s_add_u32 s4, s77, 16384
    v_bfe_u32 v63, v0, 4, 2
    v_lshlrev_b32 v60, 18, v63
    v_mfma_f32_16x16x32_bf16 v[148:151], a[8:11], a[200:203], v[148:151]
    buffer_load_dwordx4 v11, s[36:39], s4 offen offset:2048 lds
    v_mfma_f32_16x16x32_bf16 v[148:151], a[12:15], a[204:207], v[148:151]
    s_add_u32 s5, s77, 24576
    v_cvt_pk_bf16_f32 v242, v208, v209
    v_cvt_pk_bf16_f32 v243, v210, v211
    v_mfma_f32_16x16x32_bf16 v[148:151], a[16:19], a[208:211], v[148:151]
    buffer_store_dwordx4 v[240:243], v21, s[40:43], s11 offen sc1
    v_mfma_f32_16x16x32_bf16 v[148:151], a[20:23], a[212:215], v[148:151]
    ds_read_b64_tr_b16 a[44:45], v12 offset:45056
    v_bfe_u32 v61, v0, 3, 1
    v_mfma_f32_16x16x32_bf16 v[148:151], a[24:27], a[216:219], v[148:151]
    buffer_load_dwordx4 v11, s[36:39], s5 offen offset:3072 lds
    v_mfma_f32_16x16x32_bf16 v[148:151], a[28:31], a[220:223], v[148:151]
    s_load_dword s60, s[40:41], s61 glc
    s_add_u32 m0, s92, 102400
    v_mfma_f32_16x16x32_bf16 v[152:155], a[0:3], a[96:99], 0
    s_add_u32 s4, s77, 36864
    v_lshlrev_b32 v63, 1, v63
    v_lshl_add_u32 v60, v61, 8, v60
    v_mfma_f32_16x16x32_bf16 v[152:155], a[4:7], a[100:103], v[152:155]
    buffer_load_dwordx4 v11, s[36:39], s4 offen lds
    v_mfma_f32_16x16x32_bf16 v[152:155], a[8:11], a[104:107], v[152:155]
    s_add_u32 s5, s77, 45056
    v_cvt_pk_bf16_f32 v212, v148, v149
    v_cvt_pk_bf16_f32 v213, v150, v151
    v_mfma_f32_16x16x32_bf16 v[152:155], a[12:15], a[108:111], v[152:155]
    ds_read_b64_tr_b16 a[46:47], v12 offset:47104
    v_and_b32 v42, 7, v0
    v_mfma_f32_16x16x32_bf16 v[152:155], a[16:19], a[112:115], v[152:155]
    ds_read_b64_tr_b16 a[48:49], v12 offset:49152
    v_lshl_add_u32 v60, v42, 4, v60
    v_mfma_f32_16x16x32_bf16 v[152:155], a[20:23], a[116:119], v[152:155]
    buffer_load_dwordx4 v11, s[36:39], s5 offen offset:1024 lds
    v_mfma_f32_16x16x32_bf16 v[152:155], a[24:27], a[120:123], v[152:155]
    ds_read_b64_tr_b16 a[50:51], v12 offset:51200
    v_and_b32 v37, 48, v0
    v_mfma_f32_16x16x32_bf16 v[152:155], a[28:31], a[124:127], v[152:155]
    ds_read_b64_tr_b16 a[52:53], v12 offset:53248
    s_add_u32 s4, s77, 53248
    v_mfma_f32_16x16x32_bf16 v[156:159], a[0:3], a[160:163], 0
    buffer_load_dwordx4 v11, s[36:39], s4 offen offset:2048 lds
    v_mfma_f32_16x16x32_bf16 v[156:159], a[4:7], a[164:167], v[156:159]
    ds_read_b64_tr_b16 a[54:55], v12 offset:55296
    s_add_u32 s5, s77, 61440
    v_mfma_f32_16x16x32_bf16 v[156:159], a[8:11], a[168:171], v[156:159]
    s_add_u32 s11, s47, 69632
    v_cvt_pk_bf16_f32 v214, v152, v153
    v_cvt_pk_bf16_f32 v215, v154, v155
    v_mfma_f32_16x16x32_bf16 v[156:159], a[12:15], a[172:175], v[156:159]
    buffer_store_dwordx4 v[212:215], v21, s[40:43], s10 offen sc1
    v_mfma_f32_16x16x32_bf16 v[156:159], a[16:19], a[176:179], v[156:159]
    buffer_load_dwordx4 v11, s[36:39], s5 offen offset:3072 lds
    v_mfma_f32_16x16x32_bf16 v[156:159], a[20:23], a[180:183], v[156:159]
    ds_read_b64_tr_b16 a[56:57], v12 offset:57344
    s_add_u32 s8, s93, 4096
    v_mfma_f32_16x16x32_bf16 v[156:159], a[24:27], a[184:187], v[156:159]
    ds_read_b64_tr_b16 a[58:59], v12 offset:59392
    s_andn2_b32 s54, s93, 0x2000
    v_mfma_f32_16x16x32_bf16 v[156:159], a[28:31], a[188:191], v[156:159]
    ds_read_b64_tr_b16 a[60:61], v12 offset:61440
    s_bfe_u32 s10, s0, 0x10008
    v_mfma_f32_16x16x32_bf16 v[160:163], a[0:3], a[224:227], 0
    ds_read_b64_tr_b16 a[62:63], v12 offset:63488
    s_lshl_b32 s10, s10, 13
    v_mfma_f32_16x16x32_bf16 v[160:163], a[4:7], a[228:231], v[160:163]
    s_and_b32 s53, s45, 14
    s_add_u32 s10, s10, s54
    s_add_u32 s10, s10, 81920
    v_mfma_f32_16x16x32_bf16 v[160:163], a[8:11], a[232:235], v[160:163]
    s_lshr_b32 s53, s0, s53
    v_cvt_pk_bf16_f32 v216, v156, v157
    v_cvt_pk_bf16_f32 v217, v158, v159
    v_mfma_f32_16x16x32_bf16 v[160:163], a[12:15], a[236:239], v[160:163]
    s_add_u32 s48, s93, s49
    s_add_u32 s48, s48, 192
    s_bfe_i32 s53, s53, 0x10000
    v_mfma_f32_16x16x32_bf16 v[160:163], a[16:19], a[240:243], v[160:163]
    s_lshl_b32 s49, s45, 1
    v_mov_b32 v63, s53
    v_bfe_u32 v1, v63, 0, 1
    v_mfma_f32_16x16x32_bf16 v[160:163], a[20:23], a[244:247], v[160:163]
    s_and_b32 s49, s49, 15
    v_bfe_u32 v2, v63, 8, 1
    v_bfe_u32 v3, v63, 1, 1
    v_mfma_f32_16x16x32_bf16 v[160:163], a[24:27], a[248:251], v[160:163]
    s_lshr_b32 s50, s45, 3
    v_lshl_add_u32 v1, v1, 13, v60
    v_lshl_add_u32 v2, v2, 13, v60
    v_mfma_f32_16x16x32_bf16 v[160:163], a[28:31], a[252:255], v[160:163]
    s_waitcnt vmcnt(12) lgkmcnt(0)
    s_barrier
    s_add_u32 m0, s92, 0
    s_waitcnt lgkmcnt(0)
    s_cmp_lt_u32 s60, 1
    s_cbranch_scc1 L_far_p1
L_near_p1:
    s_add_u32 s5, s78, 8192
    v_mfma_f32_16x16x32_bf16 v[164:167], a[32:35], a[128:131], 0
    buffer_load_dwordx4 v[88:91], v21, s[40:43], s6 offen sc1
    v_mfma_f32_16x16x32_bf16 v[164:167], a[36:39], a[132:135], v[164:167]
    buffer_load_dwordx4 v11, s[36:39], s78 offen lds
    v_mfma_f32_16x16x32_bf16 v[164:167], a[40:43], a[136:139], v[164:167]
    s_add_u32 s6, s93, 16384
    v_cvt_pk_bf16_f32 v218, v160, v161
    v_cvt_pk_bf16_f32 v219, v162, v163
    v_mfma_f32_16x16x32_bf16 v[164:167], a[44:47], a[140:143], v[164:167]
    buffer_store_dwordx4 v[216:219], v21, s[40:43], s11 offen sc1
    v_mfma_f32_16x16x32_bf16 v[164:167], a[48:51], a[144:147], v[164:167]
    buffer_load_dwordx4 v[92:95], v21, s[40:43], s8 offen sc1
    v_mfma_f32_16x16x32_bf16 v[164:167], a[52:55], a[148:151], v[164:167]
    buffer_load_dwordx4 v11, s[36:39], s5 offen offset:1024 lds
    v_mfma_f32_16x16x32_bf16 v[164:167], a[56:59], a[152:155], v[164:167]
    ds_read_b64_tr_b16 a[64:65], v13 offset:0
    v_lshl_add_u32 v3, v3, 13, v60
    v_mfma_f32_16x16x32_bf16 v[164:167], a[60:63], a[156:159], v[164:167]
    buffer_load_dwordx4 v[96:99], v21, s[40:43], s6 offen sc1
    v_mfma_f32_16x16x32_bf16 v[168:171], a[32:35], a[192:195], 0
    s_add_u32 s4, s78, 16384
    v_bfe_u32 v4, v63, 9, 1
    v_lshl_add_u32 v4, v4, 13, v60
    v_mfma_f32_16x16x32_bf16 v[168:171], a[36:39], a[196:199], v[168:171]
    buffer_load_dwordx4 v11, s[36:39], s4 offen offset:2048 lds
    s_add_u32 s8, s93, 20480
    v_mfma_f32_16x16x32_bf16 v[168:171], a[40:43], a[200:203], v[168:171]
    buffer_load_dwordx4 v[100:103], v21, s[40:43], s8 offen sc1
    v_mfma_f32_16x16x32_bf16 v[168:171], a[44:47], a[204:207], v[168:171]
    s_add_u32 s5, s78, 24576
    v_cvt_pk_bf16_f32 v220, v164, v165
    v_cvt_pk_bf16_f32 v221, v166, v167
    v_mfma_f32_16x16x32_bf16 v[168:171], a[48:51], a[208:211], v[168:171]
    buffer_load_dwordx4 v11, s[36:39], s5 offen offset:3072 lds
    s_add_u32 s6, s93, 32768
    v_mfma_f32_16x16x32_bf16 v[168:171], a[52:55], a[212:215], v[168:171]
    buffer_load_dwordx4 v[104:107], v21, s[40:43], s6 offen sc1
    v_mfma_f32_16x16x32_bf16 v[168:171], a[56:59], a[216:219], v[168:171]
    ds_read_b64_tr_b16 a[66:67], v13 offset:2048
    v_bfe_u32 v60, v0, 4, 1
    v_mfma_f32_16x16x32_bf16 v[168:171], a[60:63], a[220:223], v[168:171]
    ds_read_b64_tr_b16 a[68:69], v13 offset:4096
    v_lshl_add_u32 v60, v60, 3, v42
    v_mfma_f32_16x16x32_bf16 v[172:175], a[32:35], a[96:99], 0
    s_add_u32 m0, s92, 4096
    s_add_u32 s4, s78, 36864
    v_mul_u32_u24 v60, 144, v60
    v_lshl_add_u32 v60, v61, 3, v60
    v_mfma_f32_16x16x32_bf16 v[172:175], a[36:39], a[100:103], v[172:175]
    buffer_load_dwordx4 v11, s[36:39], s4 offen lds
    v_mfma_f32_16x16x32_bf16 v[172:175], a[40:43], a[104:107], v[172:175]
    s_add_u32 s5, s78, 45056
    v_cvt_pk_bf16_f32 v222, v168, v169
    v_cvt_pk_bf16_f32 v223, v170, v171
    v_mfma_f32_16x16x32_bf16 v[172:175], a[44:47], a[108:111], v[172:175]
    buffer_store_dwordx4 v[220:223], v21, s[40:43], s10 offen sc1
    v_mfma_f32_16x16x32_bf16 v[172:175], a[48:51], a[112:115], v[172:175]
    ds_read_b64_tr_b16 a[70:71], v13 offset:6144
    v_bfe_u32 v61, v0, 5, 3
    v_mfma_f32_16x16x32_bf16 v[172:175], a[52:55], a[116:119], v[172:175]
    buffer_load_dwordx4 v11, s[36:39], s5 offen offset:1024 lds
    v_mfma_f32_16x16x32_bf16 v[172:175], a[56:59], a[120:123], v[172:175]
    ds_read_b64_tr_b16 a[72:73], v13 offset:8192
    v_lshl_add_u32 v72, v61, 4, v60
    v_mfma_f32_16x16x32_bf16 v[172:175], a[60:63], a[124:127], v[172:175]
    s_add_u32 s4, s78, 53248
    v_lshlrev_b32 v42, 4, v42
    v_lshrrev_b32 v60, 3, v0
    v_mfma_f32_16x16x32_bf16 v[176:179], a[32:35], a[160:163], 0
    buffer_load_dwordx4 v11, s[36:39], s4 offen offset:2048 lds
    v_mfma_f32_16x16x32_bf16 v[176:179], a[36:39], a[164:167], v[176:179]
    ds_read_b64_tr_b16 a[74:75], v13 offset:10240
    v_mul_u32_u24 v60, 144, v60
    v_mfma_f32_16x16x32_bf16 v[176:179], a[40:43], a[168:171], v[176:179]
    ds_read_b64_tr_b16 a[76:77], v13 offset:12288
    v_cvt_pk_bf16_f32 v224, v172, v173
    v_mfma_f32_16x16x32_bf16 v[176:179], a[44:47], a[172:175], v[176:179]
    ds_read_b64_tr_b16 a[78:79], v13 offset:14336
    v_cvt_pk_bf16_f32 v225, v174, v175
    v_mfma_f32_16x16x32_bf16 v[176:179], a[48:51], a[176:179], v[176:179]
    s_add_u32 s5, s78, 61440
    v_add_u32 v73, v60, v42
    v_bfe_u32 v60, v0, 3, 3
    v_mfma_f32_16x16x32_bf16 v[176:179], a[52:55], a[180:183], v[176:179]
    buffer_load_dwordx4 v11, s[36:39], s5 offen offset:3072 lds
    ds_read_b64_tr_b16 a[80:81], v13 offset:16384
    ds_read_b64_tr_b16 a[82:83], v13 offset:18432
    v_mfma_f32_16x16x32_bf16 v[176:179], a[56:59], a[184:187], v[176:179]
    ds_read_b64_tr_b16 a[84:85], v13 offset:20480
    ds_read_b64_tr_b16 a[86:87], v13 offset:22528
    v_mfma_f32_16x16x32_bf16 v[176:179], a[60:63], a[188:191], v[176:179]
    s_waitcnt vmcnt(12) lgkmcnt(4)
    buffer_store_dword v41, v59, s[40:43], s65 offen offset:128 sc1
    s_bfe_u32 s11, s0, 0x1000a
    v_mfma_f32_16x16x32_bf16 v[180:183], a[32:35], a[224:227], 0
    ds_read_b64_tr_b16 a[88:89], v13 offset:24576
    ds_read_b64_tr_b16 a[90:91], v13 offset:26624
    v_mfma_f32_16x16x32_bf16 v[180:183], a[36:39], a[228:231], v[180:183]
    ds_read_b64_tr_b16 a[92:93], v13 offset:28672
    ds_read_b64_tr_b16 a[94:95], v13 offset:30720
    v_mfma_f32_16x16x32_bf16 v[180:183], a[40:43], a[232:235], v[180:183]
    s_lshl_b32 s11, s11, 13
    v_cvt_pk_bf16_f32 v226, v176, v177
    v_cvt_pk_bf16_f32 v227, v178, v179
    v_mfma_f32_16x16x32_bf16 v[180:183], a[44:47], a[236:239], v[180:183]
    s_add_u32 s11, s11, s54
    s_add_u32 s11, s11, 86016
    v_mul_u32_u24 v60, 1152, v60
    v_add_u32 v42, v60, v42
    v_mfma_f32_16x16x32_bf16 v[180:183], a[48:51], a[240:243], v[180:183]
    buffer_store_dwordx4 v[224:227], v21, s[40:43], s11 offen sc1
    v_mfma_f32_16x16x32_bf16 v[180:183], a[52:55], a[244:247], v[180:183]
    s_bfe_u32 s10, s0, 0x1000c
    s_lshl_b32 s10, s10, 13
    s_add_u32 s10, s10, s54
    v_mfma_f32_16x16x32_bf16 v[180:183], a[56:59], a[248:251], v[180:183]
    s_add_u32 s10, s10, 98304
    s_add_u32 s61, s64, 128
    s_add_u32 s8, s93, 36864
    v_mfma_f32_16x16x32_bf16 v[180:183], a[60:63], a[252:255], v[180:183]
    s_waitcnt lgkmcnt(0)
    s_barrier
    s_add_u32 m0, s92, 32768
    v_mfma_f32_16x16x32_bf16 v[184:187], a[64:67], a[128:131], 0
    ds_read_b64_tr_b16 a[0:1], v13 offset:32768
    v_lshlrev_b32 v192, 16, v88
    v_mfma_f32_16x16x32_bf16 v[184:187], a[68:71], a[132:135], v[184:187]
    s_add_u32 s5, s79, 8192
    v_cvt_pk_bf16_f32 v228, v180, v181
    v_cvt_pk_bf16_f32 v229, v182, v183
    v_mfma_f32_16x16x32_bf16 v[184:187], a[72:75], a[136:139], v[184:187]
    buffer_load_dwordx4 v11, s[36:39], s79 offen lds
    v_mfma_f32_16x16x32_bf16 v[184:187], a[76:79], a[140:143], v[184:187]
    s_add_u32 s4, s79, 16384
    v_and_b32 v193, 0xffff0000, v88
    v_lshlrev_b32 v194, 16, v89
    v_mfma_f32_16x16x32_bf16 v[184:187], a[80:83], a[144:147], v[184:187]
    buffer_store_dwordx4 v[228:231], v21, s[40:43], s10 offen sc1
    v_mfma_f32_16x16x32_bf16 v[184:187], a[84:87], a[148:151], v[184:187]
    s_add_u32 s6, s93, 49152
    v_and_b32 v195, 0xffff0000, v89
    s_waitcnt vmcnt(13)
    v_lshlrev_b32 v196, 16, v96
    v_mfma_f32_16x16x32_bf16 v[184:187], a[88:91], a[152:155], v[184:187]
    buffer_load_dwordx4 v11, s[36:39], s5 offen offset:1024 lds
    v_mfma_f32_16x16x32_bf16 v[184:187], a[92:95], a[156:159], v[184:187]
    s_add_u32 s5, s79, 24576
    v_and_b32 v197, 0xffff0000, v96
    v_lshlrev_b32 v198, 16, v97
    v_mfma_f32_16x16x32_bf16 v[188:191], a[64:67], a[192:195], 0
    ds_read_b64_tr_b16 a[2:3], v13 offset:34816
    v_and_b32 v199, 0xffff0000, v97
    v_mfma_f32_16x16x32_bf16 v[188:191], a[68:71], a[196:199], v[188:191]
    ds_read_b64_tr_b16 a[4:5], v13 offset:36864
    v_lshlrev_b32 v204, 16, v94
    v_mfma_f32_16x16x32_bf16 v[188:191], a[72:75], a[200:203], v[188:191]
    buffer_load_dwordx4 v11, s[36:39], s4 offen offset:2048 lds
    v_mfma_f32_16x16x32_bf16 v[188:191], a[76:79], a[204:207], v[188:191]
    s_add_u32 s4, s79, 36864
    s_waitcnt vmcnt(11)
    v_lshlrev_b32 v200, 16, v104
    v_and_b32 v201, 0xffff0000, v104
    v_mfma_f32_16x16x32_bf16 v[188:191], a[80:83], a[208:211], v[188:191]
    ds_read_b64_tr_b16 a[6:7], v13 offset:38912
    v_lshlrev_b32 v202, 16, v105
    v_mfma_f32_16x16x32_bf16 v[188:191], a[84:87], a[212:215], v[188:191]
    ds_read_b64_tr_b16 a[8:9], v13 offset:40960
    v_and_b32 v203, 0xffff0000, v105
    v_mfma_f32_16x16x32_bf16 v[188:191], a[88:91], a[216:219], v[188:191]
    buffer_load_dwordx4 v11, s[36:39], s5 offen offset:3072 lds
    v_mfma_f32_16x16x32_bf16 v[188:191], a[92:95], a[220:223], v[188:191]
    s_load_dword s60, s[40:41], s61 glc
    s_add_u32 m0, s92, 36864
    v_mfma_f32_16x16x32_bf16 v[192:195], a[64:67], a[96:99], v[192:195]
    buffer_load_dwordx4 v11, s[36:39], s4 offen lds
    v_mfma_f32_16x16x32_bf16 v[192:195], a[68:71], a[100:103], v[192:195]
    ds_read_b64_tr_b16 a[10:11], v13 offset:43008
    v_and_b32 v205, 0xffff0000, v94
    v_mfma_f32_16x16x32_bf16 v[192:195], a[72:75], a[104:107], v[192:195]
    ds_read_b64_tr_b16 a[12:13], v13 offset:45056
    v_lshlrev_b32 v206, 16, v95
    v_mfma_f32_16x16x32_bf16 v[192:195], a[76:79], a[108:111], v[192:195]
    s_add_u32 s5, s79, 45056
    v_and_b32 v207, 0xffff0000, v95
    v_lshlrev_b32 v208, 16, v102
    v_mfma_f32_16x16x32_bf16 v[192:195], a[80:83], a[112:115], v[192:195]
    buffer_load_dwordx4 v11, s[36:39], s5 offen offset:1024 lds
    v_mfma_f32_16x16x32_bf16 v[192:195], a[84:87], a[116:119], v[192:195]
    ds_read_b64_tr_b16 a[14:15], v13 offset:47104
    v_and_b32 v209, 0xffff0000, v102
    v_mfma_f32_16x16x32_bf16 v[192:195], a[88:91], a[120:123], v[192:195]
    ds_read_b64_tr_b16 a[16:17], v13 offset:49152
    v_lshlrev_b32 v210, 16, v103
    v_mfma_f32_16x16x32_bf16 v[192:195], a[92:95], a[124:127], v[192:195]
    ds_read_b64_tr_b16 a[18:19], v13 offset:51200
    v_and_b32 v211, 0xffff0000, v103
    v_mfma_f32_16x16x32_bf16 v[196:199], a[64:67], a[160:163], v[196:199]
    s_add_u32 s4, s79, 53248
    v_lshlrev_b32 v148, 16, v90
    v_and_b32 v149, 0xffff0000, v90
    v_mfma_f32_16x16x32_bf16 v[196:199], a[68:71], a[164:167], v[196:199]
    buffer_load_dwordx4 v11, s[36:39], s4 offen offset:2048 lds
    v_mfma_f32_16x16x32_bf16 v[196:199], a[72:75], a[168:171], v[196:199]
    ds_read_b64_tr_b16 a[20:21], v13 offset:53248
    v_lshlrev_b32 v150, 16, v91
    v_mfma_f32_16x16x32_bf16 v[196:199], a[76:79], a[172:175], v[196:199]
    ds_read_b64_tr_b16 a[22:23], v13 offset:55296
    v_and_b32 v151, 0xffff0000, v91
    v_mfma_f32_16x16x32_bf16 v[196:199], a[80:83], a[176:179], v[196:199]
    s_add_u32 s5, s79, 61440
    v_lshlrev_b32 v68, 16, v92
    v_and_b32 v69, 0xffff0000, v92
    v_mfma_f32_16x16x32_bf16 v[196:199], a[84:87], a[180:183], v[196:199]
    buffer_load_dwordx4 v11, s[36:39], s5 offen offset:3072 lds
    v_mfma_f32_16x16x32_bf16 v[196:199], a[88:91], a[184:187], v[196:199]
    ds_read_b64_tr_b16 a[24:25], v13 offset:57344
    v_lshlrev_b32 v70, 16, v93
    v_mfma_f32_16x16x32_bf16 v[196:199], a[92:95], a[188:191], v[196:199]
    ds_read_b64_tr_b16 a[26:27], v13 offset:59392
    v_and_b32 v71, 0xffff0000, v93
    v_mfma_f32_16x16x32_bf16 v[200:203], a[64:67], a[224:227], v[200:203]
    ds_read_b64_tr_b16 a[28:29], v13 offset:61440
    v_lshlrev_b32 v152, 16, v98
    v_mfma_f32_16x16x32_bf16 v[200:203], a[68:71], a[228:231], v[200:203]
    ds_read_b64_tr_b16 a[30:31], v13 offset:63488
    v_and_b32 v153, 0xffff0000, v98
    v_mfma_f32_16x16x32_bf16 v[200:203], a[72:75], a[232:235], v[200:203]
    s_bfe_u32 s11, s0, 0x10002
    v_lshlrev_b32 v154, 16, v99
    v_and_b32 v155, 0xffff0000, v99
    v_mfma_f32_16x16x32_bf16 v[200:203], a[76:79], a[236:239], v[200:203]
    s_lshl_b32 s11, s11, 13
    v_lshlrev_b32 v156, 16, v106
    v_and_b32 v157, 0xffff0000, v106
    v_mfma_f32_16x16x32_bf16 v[200:203], a[80:83], a[240:243], v[200:203]
    s_add_u32 s11, s11, s54
    v_lshlrev_b32 v158, 16, v107
    v_and_b32 v159, 0xffff0000, v107
    v_mfma_f32_16x16x32_bf16 v[200:203], a[84:87], a[244:247], v[200:203]
    s_add_u32 s11, s11, 4096
    v_add_f32 v184, v184, v68
    v_add_f32 v185, v185, v69
    v_mfma_f32_16x16x32_bf16 v[200:203], a[88:91], a[248:251], v[200:203]
    s_bfe_u32 s10, s0, 0x10006
    v_add_f32 v186, v186, v70
    v_add_f32 v187, v187, v71
    v_mfma_f32_16x16x32_bf16 v[200:203], a[92:95], a[252:255], v[200:203]
    s_waitcnt vmcnt(11) lgkmcnt(0)
    s_barrier
    s_lshl_b32 s10, s10, 13
    s_waitcnt lgkmcnt(0)
    s_cmp_lt_u32 s60, 2
    s_cbranch_scc1 L_far_p2
L_near_p2:
    s_add_u32 s10, s10, s54
    v_mfma_f32_16x16x32_bf16 v[204:207], a[0:3], a[128:131], v[204:207]
    buffer_load_dwordx4 v[108:111], v21, s[40:43], s8 offen sc1
    v_mfma_f32_16x16x32_bf16 v[204:207], a[4:7], a[132:135], v[204:207]
    ds_read_b64_tr_b16 a[32:33], v12 offset:0
    v_lshlrev_b32 v64, 16, v100
    v_mfma_f32_16x16x32_bf16 v[204:207], a[8:11], a[136:139], v[204:207]
    ds_read_b64_tr_b16 a[34:35], v12 offset:2048
    v_and_b32 v65, 0xffff0000, v100
    v_mfma_f32_16x16x32_bf16 v[204:207], a[12:15], a[140:143], v[204:207]
    ds_read_b64_tr_b16 a[36:37], v12 offset:4096
    v_lshlrev_b32 v66, 16, v101
    v_mfma_f32_16x16x32_bf16 v[204:207], a[16:19], a[144:147], v[204:207]
    buffer_load_dwordx4 v[112:115], v21, s[40:43], s6 offen sc1
    v_mfma_f32_16x16x32_bf16 v[204:207], a[20:23], a[148:151], v[204:207]
    s_add_u32 s8, s93, 53248
    v_cvt_pk_bf16_f32 v92, v184, v185
    v_and_b32 v67, 0xffff0000, v101
    v_mfma_f32_16x16x32_bf16 v[204:207], a[24:27], a[152:155], v[204:207]
    buffer_load_dwordx4 v[116:119], v21, s[40:43], s8 offen sc1
    v_mfma_f32_16x16x32_bf16 v[204:207], a[28:31], a[156:159], v[204:207]
    ds_read_b64_tr_b16 a[38:39], v12 offset:6144
    v_cvt_pk_bf16_f32 v93, v186, v187
    v_mfma_f32_16x16x32_bf16 v[208:211], a[0:3], a[192:195], v[208:211]
    s_add_u32 s6, s93, 65536
    v_add_f32 v188, v188, v64
    v_add_f32 v189, v189, v65
    v_mfma_f32_16x16x32_bf16 v[208:211], a[4:7], a[196:199], v[208:211]
    buffer_load_dwordx4 v[120:123], v21, s[40:43], s6 offen sc1
    v_mfma_f32_16x16x32_bf16 v[208:211], a[8:11], a[200:203], v[208:211]
    ds_read_b64_tr_b16 a[40:41], v12 offset:8192
    v_cvt_pk_bf16_f32 v94, v204, v205
    v_mfma_f32_16x16x32_bf16 v[208:211], a[12:15], a[204:207], v[208:211]
    ds_read_b64_tr_b16 a[42:43], v12 offset:10240
    v_cvt_pk_bf16_f32 v95, v206, v207
    v_mfma_f32_16x16x32_bf16 v[208:211], a[16:19], a[208:211], v[208:211]
    s_add_u32 s8, s93, 69632
    v_add_f32 v190, v190, v66
    v_add_f32 v191, v191, v67
    v_mfma_f32_16x16x32_bf16 v[208:211], a[20:23], a[212:215], v[208:211]
    buffer_load_dwordx4 v[124:127], v21, s[40:43], s8 offen sc1
    v_mfma_f32_16x16x32_bf16 v[208:211], a[24:27], a[216:219], v[208:211]
    ds_read_b64_tr_b16 a[44:45], v12 offset:12288
    v_cvt_pk_bf16_f32 v100, v188, v189
    v_mfma_f32_16x16x32_bf16 v[208:211], a[28:31], a[220:223], v[208:211]
    ds_read_b64_tr_b16 a[46:47], v12 offset:14336
    v_cvt_pk_bf16_f32 v101, v190, v191
    v_mfma_f32_16x16x32_bf16 v[148:151], a[0:3], a[96:99], v[148:151]
    ds_read_b64_tr_b16 a[48:49], v12 offset:16384
    v_cvt_pk_bf16_f32 v88, v192, v193
    v_mfma_f32_16x16x32_bf16 v[148:151], a[4:7], a[100:103], v[148:151]
    ds_read_b64_tr_b16 a[50:51], v12 offset:18432
    v_cvt_pk_bf16_f32 v89, v194, v195
    v_mfma_f32_16x16x32_bf16 v[148:151], a[8:11], a[104:107], v[148:151]
    ds_read_b64_tr_b16 a[52:53], v12 offset:20480
    v_cvt_pk_bf16_f32 v102, v208, v209
    v_mfma_f32_16x16x32_bf16 v[148:151], a[12:15], a[108:111], v[148:151]
    ds_read_b64_tr_b16 a[54:55], v12 offset:22528
    v_cvt_pk_bf16_f32 v103, v210, v211
    v_mfma_f32_16x16x32_bf16 v[148:151], a[16:19], a[112:115], v[148:151]
    ds_read_b64_tr_b16 a[56:57], v12 offset:24576
    v_cvt_pk_bf16_f32 v96, v196, v197
    v_mfma_f32_16x16x32_bf16 v[148:151], a[20:23], a[116:119], v[148:151]
    ds_read_b64_tr_b16 a[58:59], v12 offset:26624
    v_cvt_pk_bf16_f32 v97, v198, v199
    v_mfma_f32_16x16x32_bf16 v[148:151], a[24:27], a[120:123], v[148:151]
    ds_read_b64_tr_b16 a[60:61], v12 offset:28672
    v_cvt_pk_bf16_f32 v104, v200, v201
    v_mfma_f32_16x16x32_bf16 v[148:151], a[28:31], a[124:127], v[148:151]
    ds_read_b64_tr_b16 a[62:63], v12 offset:30720
    v_cvt_pk_bf16_f32 v105, v202, v203
    v_mfma_f32_16x16x32_bf16 v[152:155], a[0:3], a[160:163], v[152:155]
    buffer_store_dwordx4 v[92:95], v21, s[40:43], s11 offen sc1
    v_mfma_f32_16x16x32_bf16 v[152:155], a[4:7], a[164:167], v[152:155]
    s_add_u32 s10, s10, 20480
    s_bfe_u32 s11, s0, 0x10000
    s_lshl_b32 s11, s11, 13
    v_mfma_f32_16x16x32_bf16 v[152:155], a[8:11], a[168:171], v[152:155]
    buffer_store_dwordx4 v[100:103], v21, s[40:43], s10 offen sc1
    v_mfma_f32_16x16x32_bf16 v[152:155], a[12:15], a[172:175], v[152:155]
    s_add_u32 s11, s11, s54
    v_cvt_pk_bf16_f32 v90, v148, v149
    v_cvt_pk_bf16_f32 v91, v150, v151
    v_mfma_f32_16x16x32_bf16 v[152:155], a[16:19], a[176:179], v[152:155]
    s_add_u32 s11, s11, 0
    s_bfe_u32 s10, s0, 0x10004
    s_lshl_b32 s10, s10, 13
    v_mfma_f32_16x16x32_bf16 v[152:155], a[20:23], a[180:183], v[152:155]
    buffer_store_dwordx4 v[88:91], v21, s[40:43], s11 offen sc1
    v_mfma_f32_16x16x32_bf16 v[152:155], a[24:27], a[184:187], v[152:155]
    s_add_u32 s10, s10, s54
    s_add_u32 s10, s10, 16384
    s_bfe_u32 s11, s0, 0x10008
    v_mfma_f32_16x16x32_bf16 v[152:155], a[28:31], a[188:191], v[152:155]
    s_lshl_b32 s11, s11, 13
    s_add_u32 s11, s11, s54
    s_add_u32 s11, s11, 32768
    v_mfma_f32_16x16x32_bf16 v[156:159], a[0:3], a[224:227], v[156:159]
    s_add_u32 s49, s49, s50
    s_lshl_b32 s50, s44, 21
    s_lshl2_add_u32 s49, s49, s50
    v_mfma_f32_16x16x32_bf16 v[156:159], a[4:7], a[228:231], v[156:159]
    s_and_b32 s52, s45, 1
    s_lshr_b32 s51, s45, 1
    s_lshl_b32 s50, s44, 21
    v_mfma_f32_16x16x32_bf16 v[156:159], a[8:11], a[232:235], v[156:159]
    s_lshl_b32 s53, s3, 10
    v_cvt_pk_bf16_f32 v98, v152, v153
    v_cvt_pk_bf16_f32 v99, v154, v155
    v_mfma_f32_16x16x32_bf16 v[156:159], a[12:15], a[236:239], v[156:159]
    buffer_store_dwordx4 v[96:99], v21, s[40:43], s10 offen sc1
    v_mfma_f32_16x16x32_bf16 v[156:159], a[16:19], a[240:243], v[156:159]
    s_bfe_u32 s10, s0, 0x1000a
    s_lshl_b32 s10, s10, 13
    s_add_u32 s10, s10, s54
    v_mfma_f32_16x16x32_bf16 v[156:159], a[20:23], a[244:247], v[156:159]
    s_add_u32 s50, s50, s53
    s_lshl_b32 s53, s52, 7
    s_add_u32 s10, s10, 36864
    v_mfma_f32_16x16x32_bf16 v[156:159], a[24:27], a[248:251], v[156:159]
    s_add_u32 s50, s50, s53
    s_lshl_b32 s51, s51, 2
    s_or_b32 s51, s51, 0x40000
    v_mfma_f32_16x16x32_bf16 v[156:159], a[28:31], a[252:255], v[156:159]
    s_waitcnt vmcnt(9) lgkmcnt(0)
    s_barrier
    s_bfe_u32 s53, 0xdc985410, s51
    v_mfma_f32_16x16x32_bf16 v[160:163], a[32:35], a[128:131], 0
    ds_read_b64_tr_b16 a[64:65], v12 offset:32768
    s_waitcnt vmcnt(8)
    v_lshlrev_b32 v68, 16, v108
    v_mfma_f32_16x16x32_bf16 v[160:163], a[36:39], a[132:135], v[160:163]
    s_lshl_b32 s53, s53, 12
    v_cvt_pk_bf16_f32 v106, v156, v157
    v_cvt_pk_bf16_f32 v107, v158, v159
    v_mfma_f32_16x16x32_bf16 v[160:163], a[40:43], a[136:139], v[160:163]
    ds_read_b64_tr_b16 a[66:67], v12 offset:34816
    v_and_b32 v69, 0xffff0000, v108
    v_mfma_f32_16x16x32_bf16 v[160:163], a[44:47], a[140:143], v[160:163]
    s_add_u32 s80, s50, s53
    s_waitcnt vmcnt(7)
    v_lshlrev_b32 v168, 16, v112
    v_and_b32 v169, 0xffff0000, v112
    v_mfma_f32_16x16x32_bf16 v[160:163], a[48:51], a[144:147], v[160:163]
    buffer_store_dwordx4 v[104:107], v21, s[40:43], s11 offen sc1
    v_mfma_f32_16x16x32_bf16 v[160:163], a[52:55], a[148:151], v[160:163]
    s_bfe_u32 s11, s0, 0x1000c
    v_lshlrev_b32 v170, 16, v113
    v_and_b32 v171, 0xffff0000, v113
    v_mfma_f32_16x16x32_bf16 v[160:163], a[56:59], a[152:155], v[160:163]
    ds_read_b64_tr_b16 a[68:69], v12 offset:36864
    v_lshlrev_b32 v172, 16, v114
    v_mfma_f32_16x16x32_bf16 v[160:163], a[60:63], a[156:159], v[160:163]
    s_lshl_b32 s11, s11, 13
    v_and_b32 v173, 0xffff0000, v114
    v_lshlrev_b32 v174, 16, v115
    v_mfma_f32_16x16x32_bf16 v[164:167], a[32:35], a[192:195], 0
    ds_read_b64_tr_b16 a[70:71], v12 offset:38912
    v_and_b32 v175, 0xffff0000, v115
    v_mfma_f32_16x16x32_bf16 v[164:167], a[36:39], a[196:199], v[164:167]
    s_add_u32 s11, s11, s54
    s_waitcnt vmcnt(7)
    v_lshlrev_b32 v176, 16, v116
    v_and_b32 v177, 0xffff0000, v116
    v_mfma_f32_16x16x32_bf16 v[164:167], a[40:43], a[200:203], v[164:167]
    ds_read_b64_tr_b16 a[72:73], v12 offset:40960
    v_lshlrev_b32 v178, 16, v117
    v_mfma_f32_16x16x32_bf16 v[164:167], a[44:47], a[204:207], v[164:167]
    ds_read_b64_tr_b16 a[74:75], v12 offset:43008
    v_and_b32 v179, 0xffff0000, v117
    v_mfma_f32_16x16x32_bf16 v[164:167], a[48:51], a[208:211], v[164:167]
    ds_read_b64_tr_b16 a[76:77], v12 offset:45056
    v_lshlrev_b32 v70, 16, v109
    v_mfma_f32_16x16x32_bf16 v[164:167], a[52:55], a[212:215], v[164:167]
    ds_read_b64_tr_b16 a[78:79], v12 offset:47104
    v_and_b32 v71, 0xffff0000, v109
    v_mfma_f32_16x16x32_bf16 v[164:167], a[56:59], a[216:219], v[164:167]
    ds_read_b64_tr_b16 a[80:81], v12 offset:49152
    v_lshlrev_b32 v64, 16, v110
    v_mfma_f32_16x16x32_bf16 v[164:167], a[60:63], a[220:223], v[164:167]
    ds_read_b64_tr_b16 a[82:83], v12 offset:51200
    v_lshlrev_b32 v180, 16, v118
    v_mfma_f32_16x16x32_bf16 v[168:171], a[32:35], a[96:99], v[168:171]
    ds_read_b64_tr_b16 a[84:85], v12 offset:53248
    v_and_b32 v181, 0xffff0000, v118
    v_mfma_f32_16x16x32_bf16 v[168:171], a[36:39], a[100:103], v[168:171]
    ds_read_b64_tr_b16 a[86:87], v12 offset:55296
    v_lshlrev_b32 v182, 16, v119
    v_mfma_f32_16x16x32_bf16 v[168:171], a[40:43], a[104:107], v[168:171]
    ds_read_b64_tr_b16 a[88:89], v12 offset:57344
    v_and_b32 v183, 0xffff0000, v119
    v_mfma_f32_16x16x32_bf16 v[168:171], a[44:47], a[108:111], v[168:171]
    ds_read_b64_tr_b16 a[90:91], v12 offset:59392
    v_and_b32 v65, 0xffff0000, v110
    v_mfma_f32_16x16x32_bf16 v[168:171], a[48:51], a[112:115], v[168:171]
    ds_read_b64_tr_b16 a[92:93], v12 offset:61440
    v_lshlrev_b32 v66, 16, v111
    v_mfma_f32_16x16x32_bf16 v[168:171], a[52:55], a[116:119], v[168:171]
    ds_read_b64_tr_b16 a[94:95], v12 offset:63488
    v_and_b32 v67, 0xffff0000, v111
    v_mfma_f32_16x16x32_bf16 v[168:171], a[56:59], a[120:123], v[168:171]
    s_add_u32 s11, s11, 49152
    v_add_f32 v160, v160, v68
    v_add_f32 v161, v161, v69
    v_mfma_f32_16x16x32_bf16 v[168:171], a[60:63], a[124:127], v[168:171]
    s_bfe_u32 s53, 0x08541010, s51
    v_add_f32 v162, v162, v70
    v_add_f32 v163, v163, v71
    v_mfma_f32_16x16x32_bf16 v[172:175], a[32:35], a[160:163], v[172:175]
    s_add_u32 s53, s53, 16
    v_add_f32 v164, v164, v64
    v_add_f32 v165, v165, v65
    v_mfma_f32_16x16x32_bf16 v[172:175], a[36:39], a[164:167], v[172:175]
    s_lshl_b32 s53, s53, 12
    v_add_f32 v166, v166, v66
    v_add_f32 v167, v167, v67
    v_mfma_f32_16x16x32_bf16 v[172:175], a[40:43], a[168:171], v[172:175]
    s_add_u32 s84, s50, s53
    s_waitcnt vmcnt(6)
    v_lshlrev_b32 v184, 16, v120
    v_and_b32 v185, 0xffff0000, v120
    v_mfma_f32_16x16x32_bf16 v[172:175], a[44:47], a[172:175], v[172:175]
    s_bfe_u32 s53, 0x40004400, s51
    v_lshlrev_b32 v186, 16, v121
    v_and_b32 v187, 0xffff0000, v121
    v_mfma_f32_16x16x32_bf16 v[172:175], a[48:51], a[176:179], v[172:175]
    s_lshl_b32 s53, s53, 28
    v_cvt_pk_bf16_f32 v108, v160, v161
    v_cvt_pk_bf16_f32 v109, v162, v163
    v_mfma_f32_16x16x32_bf16 v[172:175], a[52:55], a[180:183], v[172:175]
    s_mul_i32 s55, s44, 92160
    v_cvt_pk_bf16_f32 v110, v164, v165
    v_cvt_pk_bf16_f32 v111, v166, v167
    v_mfma_f32_16x16x32_bf16 v[172:175], a[56:59], a[184:187], v[172:175]
    buffer_store_dwordx4 v[108:111], v21, s[40:43], s10 offen sc1
    v_mfma_f32_16x16x32_bf16 v[172:175], a[60:63], a[188:191], v[172:175]
    s_bfe_u32 s10, s0, 0x1000e
    v_lshlrev_b32 v188, 16, v122
    v_and_b32 v189, 0xffff0000, v122
    v_mfma_f32_16x16x32_bf16 v[176:179], a[32:35], a[224:227], v[176:179]
    s_lshl_b32 s10, s10, 13
    v_lshlrev_b32 v190, 16, v123
    v_and_b32 v191, 0xffff0000, v123
    v_mfma_f32_16x16x32_bf16 v[176:179], a[36:39], a[228:231], v[176:179]
    s_add_u32 s10, s10, s54
    v_cvt_pk_bf16_f32 v112, v168, v169
    v_cvt_pk_bf16_f32 v113, v170, v171
    v_mfma_f32_16x16x32_bf16 v[176:179], a[40:43], a[232:235], v[176:179]
    s_add_u32 s10, s10, 53248
    v_cvt_pk_bf16_f32 v114, v172, v173
    v_cvt_pk_bf16_f32 v115, v174, v175
    v_mfma_f32_16x16x32_bf16 v[176:179], a[44:47], a[236:239], v[176:179]
    buffer_store_dwordx4 v[112:115], v21, s[40:43], s11 offen sc1
    v_mfma_f32_16x16x32_bf16 v[176:179], a[48:51], a[240:243], v[176:179]
    s_mul_i32 s56, s46, 0x10011111
    s_waitcnt vmcnt(7)
    v_lshlrev_b32 v192, 16, v124
    v_and_b32 v193, 0xffff0000, v124
    v_mfma_f32_16x16x32_bf16 v[176:179], a[52:55], a[244:247], v[176:179]
    s_xor_b32 s56, s56, 0x22200000
    v_lshlrev_b32 v194, 16, v125
    v_and_b32 v195, 0xffff0000, v125
    v_mfma_f32_16x16x32_bf16 v[176:179], a[56:59], a[248:251], v[176:179]
    s_bfe_u32 s56, s56, s51
    v_add_u32 v5, s53, v1
    v_add_u32 v6, s53, v2
    v_mfma_f32_16x16x32_bf16 v[176:179], a[60:63], a[252:255], v[176:179]
    s_bfe_u32 s53, 0x40000044, s51
    v_lshlrev_b32 v196, 16, v126
    v_and_b32 v197, 0xffff0000, v126
    s_waitcnt lgkmcnt(0)
    v_mfma_f32_16x16x32_bf16 v[180:183], a[64:67], a[128:131], v[180:183]
    s_lshl_b32 s53, s53, 28
    v_lshlrev_b32 v198, 16, v127
    v_and_b32 v199, 0xffff0000, v127
    v_mfma_f32_16x16x32_bf16 v[180:183], a[68:71], a[132:135], v[180:183]
    s_mul_i32 s57, s46, 0x41100000
    v_add_u32 v7, s53, v3
    v_add_u32 v8, s53, v4
    v_mfma_f32_16x16x32_bf16 v[180:183], a[72:75], a[136:139], v[180:183]
    s_mul_i32 s53, s52, 9216
    v_cvt_pk_bf16_f32 v116, v176, v177
    v_cvt_pk_bf16_f32 v117, v178, v179
    v_mfma_f32_16x16x32_bf16 v[180:183], a[76:79], a[140:143], v[180:183]
    s_add_u32 s55, s55, s53
    s_xor_b32 s57, s57, 0x42041302
    s_bfe_u32 s57, s57, s51
    v_mfma_f32_16x16x32_bf16 v[180:183], a[80:83], a[144:147], v[180:183]
    s_and_b32 s53, s3, 2
    s_lshl1_add_u32 s56, s53, s56
    s_add_u32 s56, s56, s1
    v_mfma_f32_16x16x32_bf16 v[180:183], a[84:87], a[148:151], v[180:183]
    s_add_u32 s53, s56, 7
    s_lshr_b32 s53, s53, 4
    s_mul_i32 s53, s53, 9
    v_mfma_f32_16x16x32_bf16 v[180:183], a[88:91], a[152:155], v[180:183]
    s_sub_u32 s56, s56, s53
    s_lshl_b32 s56, s56, 7
    s_mul_i32 s57, s57, 18432
    v_mfma_f32_16x16x32_bf16 v[180:183], a[92:95], a[156:159], v[180:183]
    s_lshl_b32 s63, s52, 2
    s_lshr_b32 s63, s0, s63
    s_add_u32 s56, s56, s57
    v_mfma_f32_16x16x32_bf16 v[184:187], a[64:67], a[192:195], v[184:187]
    s_bfe_u32 s11, s63, 0x10000
    s_lshl_b32 s11, s11, 13
    v_add_u32 v74, s56, v42
    v_mfma_f32_16x16x32_bf16 v[184:187], a[68:71], a[196:199], v[184:187]
    s_mul_i32 s56, s46, 0x8000000
    s_add_u32 s11, s11, s54
    s_add_u32 s11, s11, 65536
    v_mfma_f32_16x16x32_bf16 v[184:187], a[72:75], a[200:203], v[184:187]
    s_xor_b32 s56, s56, 0x8887733
    v_cvt_pk_bf16_f32 v118, v180, v181
    v_cvt_pk_bf16_f32 v119, v182, v183
    v_mfma_f32_16x16x32_bf16 v[184:187], a[76:79], a[204:207], v[184:187]
    buffer_store_dwordx4 v[116:119], v21, s[40:43], s10 offen sc1
    v_mfma_f32_16x16x32_bf16 v[184:187], a[80:83], a[208:211], v[184:187]
    s_bfe_u32 s56, s56, s51
    s_mul_i32 s57, s46, 0xc117373
    s_xor_b32 s57, s57, 0x84203131
    v_mfma_f32_16x16x32_bf16 v[184:187], a[84:87], a[212:215], v[184:187]
    s_bfe_u32 s57, s57, s51
    s_and_b32 s53, s3, 2
    s_lshl2_add_u32 s57, s53, s57
    v_mfma_f32_16x16x32_bf16 v[184:187], a[88:91], a[216:219], v[184:187]
    s_add_u32 s56, s56, s1
    s_add_u32 s53, s56, 7
    s_lshr_b32 s53, s53, 4
    v_mfma_f32_16x16x32_bf16 v[184:187], a[92:95], a[220:223], v[184:187]
    s_mul_i32 s53, s53, 9
    s_sub_u32 s56, s56, s53
    s_lshl_b32 s56, s56, 7
    v_mfma_f32_16x16x32_bf16 v[188:191], a[64:67], a[96:99], v[188:191]
    s_lshr_b32 s53, s57, 3
    s_lshl_b32 s53, s53, 22
    s_add_u32 s56, s56, s53
    v_mfma_f32_16x16x32_bf16 v[188:191], a[68:71], a[100:103], v[188:191]
    s_mul_i32 s57, s57, 18432
    s_add_u32 s56, s56, s57
    s_lshl_b32 s62, s45, 3
    v_mfma_f32_16x16x32_bf16 v[188:191], a[72:75], a[104:107], v[188:191]
    s_and_b32 s62, s62, 16
    v_cvt_pk_bf16_f32 v120, v184, v185
    v_cvt_pk_bf16_f32 v121, v186, v187
    v_mfma_f32_16x16x32_bf16 v[188:191], a[76:79], a[108:111], v[188:191]
    s_bfe_u32 s10, s63, 0x10002
    s_lshl_b32 s62, 0xffff, s62
    v_add_u32 v75, s56, v42
    v_mfma_f32_16x16x32_bf16 v[188:191], a[80:83], a[112:115], v[188:191]
    s_lshl_b32 s10, s10, 13
    s_add_u32 s10, s10, s54
    v_mov_b32 v41, s62
    v_mfma_f32_16x16x32_bf16 v[188:191], a[84:87], a[116:119], v[188:191]
    s_add_u32 s82, s80, 131072
    s_add_u32 s86, s84, 131072
    s_add_u32 s10, s10, 69632
    v_mfma_f32_16x16x32_bf16 v[188:191], a[88:91], a[120:123], v[188:191]
    s_add_u32 s81, s80, 1048576
    s_add_u32 s83, s82, 1048576
    s_add_u32 s85, s84, 1048576
    v_mfma_f32_16x16x32_bf16 v[188:191], a[92:95], a[124:127], v[188:191]
    s_load_dwordx16 s[24:39], s[40:41], s48 glc
    s_add_u32 s87, s86, 1048576
    v_mfma_f32_16x16x32_bf16 v[192:195], a[64:67], a[160:163], v[192:195]
    s_mov_b64 s[88:89], 0
    s_mov_b64 s[90:91], 0
    s_mov_b64 s[72:73], 0
    v_mfma_f32_16x16x32_bf16 v[192:195], a[68:71], a[164:167], v[192:195]
    s_mov_b64 s[74:75], 0
    v_cvt_pk_bf16_f32 v122, v188, v189
    v_cvt_pk_bf16_f32 v123, v190, v191
    v_mfma_f32_16x16x32_bf16 v[192:195], a[72:75], a[168:171], v[192:195]
    buffer_store_dwordx4 v[120:123], v21, s[40:43], s11 offen sc1
    v_mfma_f32_16x16x32_bf16 v[192:195], a[76:79], a[172:175], v[192:195]
    s_add_u32 s49, s49, 114880
    v_mfma_f32_16x16x32_bf16 v[192:195], a[80:83], a[176:179], v[192:195]
    v_mfma_f32_16x16x32_bf16 v[192:195], a[84:87], a[180:183], v[192:195]
    v_mfma_f32_16x16x32_bf16 v[192:195], a[88:91], a[184:187], v[192:195]
    v_mfma_f32_16x16x32_bf16 v[192:195], a[92:95], a[188:191], v[192:195]
    s_nop 2
    v_mfma_f32_16x16x32_bf16 v[196:199], a[64:67], a[224:227], v[196:199]
    s_nop 1
    v_mfma_f32_16x16x32_bf16 v[196:199], a[68:71], a[228:231], v[196:199]
    v_mfma_f32_16x16x32_bf16 v[196:199], a[72:75], a[232:235], v[196:199]
    v_cvt_pk_bf16_f32 v124, v192, v193
    v_cvt_pk_bf16_f32 v125, v194, v195
    v_mfma_f32_16x16x32_bf16 v[196:199], a[76:79], a[236:239], v[196:199]
    v_mfma_f32_16x16x32_bf16 v[196:199], a[80:83], a[240:243], v[196:199]
    v_mfma_f32_16x16x32_bf16 v[196:199], a[84:87], a[244:247], v[196:199]
    v_mfma_f32_16x16x32_bf16 v[196:199], a[88:91], a[248:251], v[196:199]
    v_mfma_f32_16x16x32_bf16 v[196:199], a[92:95], a[252:255], v[196:199]
    s_nop 7
    v_cvt_pk_bf16_f32 v126, v196, v197
    v_cvt_pk_bf16_f32 v127, v198, v199
    buffer_store_dwordx4 v[124:127], v21, s[40:43], s10 offen sc1
    s_nop 0
    s_mov_b32 s6, 0
    s_waitcnt lgkmcnt(0)
    s_or_b32 vcc_lo, s24, s28
    s_or_b32 vcc_hi, s32, s36
    s_andn2_b64 exec, vcc, s[88:89]
    s_cbranch_execz L_tp_0
    s_or_b64 s[88:89], s[88:89], vcc
    buffer_load_dwordx4 v[212:215], v1, s[40:43], s80 offen offset:0 sc1
    buffer_load_dwordx4 v[216:219], v1, s[40:43], s80 offen offset:512 sc1
    buffer_load_dwordx4 v[128:131], v5, s[40:43], s84 offen offset:0 sc1
    buffer_load_dwordx4 v[132:135], v5, s[40:43], s84 offen offset:512 sc1
    s_add_u32 s6, s6, 1
L_tp_0:
    s_or_b32 vcc_lo, s25, s29
    s_or_b32 vcc_hi, s33, s37
    s_andn2_b64 exec, vcc, s[90:91]
    s_cbranch_execz L_tp_1
    s_or_b64 s[90:91], s[90:91], vcc
    buffer_load_dwordx4 v[220:223], v2, s[40:43], s81 offen offset:0 sc1
    buffer_load_dwordx4 v[224:227], v2, s[40:43], s81 offen offset:512 sc1
    buffer_load_dwordx4 v[136:139], v6, s[40:43], s85 offen offset:0 sc1
    buffer_load_dwordx4 v[140:143], v6, s[40:43], s85 offen offset:512 sc1
    s_add_u32 s6, s6, 1
L_tp_1:
    s_or_b32 vcc_lo, s26, s30
    s_or_b32 vcc_hi, s34, s38
    s_andn2_b64 exec, vcc, s[72:73]
    s_cbranch_execz L_tp_2
    s_or_b64 s[72:73], s[72:73], vcc
    buffer_load_dwordx4 v[228:231], v3, s[40:43], s82 offen offset:0 sc1
    buffer_load_dwordx4 v[232:235], v3, s[40:43], s82 offen offset:512 sc1
    buffer_load_dwordx4 v[80:83], v7, s[40:43], s86 offen offset:0 sc1
    buffer_load_dwordx4 v[84:87], v7, s[40:43], s86 offen offset:512 sc1
    s_add_u32 s6, s6, 1
L_tp_2:
    s_mov_b64 exec, -1
    s_waitcnt vmcnt(12)
    s_cmp_ge_u32 s6, 3
    s_cbranch_scc1 L_drained
    s_waitcnt vmcnt(8)
    s_cmp_ge_u32 s6, 2
    s_cbranch_scc1 L_drained
    s_waitcnt vmcnt(4)
    s_cmp_ge_u32 s6, 1
    s_cbranch_scc1 L_drained
    s_waitcnt vmcnt(0)
L_drained:
    s_barrier
    buffer_store_dword v41, v36, s[40:43], s49 offen sc1
    s_mov_b32 s7, 400000
L_gather:
    s_load_dwordx16 s[24:39], s[40:41], s48 glc
    s_waitcnt lgkmcnt(0)
    s_or_b32 vcc_lo, s24, s28
    s_or_b32 vcc_hi, s32, s36
    s_andn2_b64 exec, vcc, s[88:89]
    s_cbranch_execz L_tg_0
    s_or_b64 s[88:89], s[88:89], vcc
    buffer_load_dwordx4 v[212:215], v1, s[40:43], s80 offen offset:0 sc1
    buffer_load_dwordx4 v[216:219], v1, s[40:43], s80 offen offset:512 sc1
    buffer_load_dwordx4 v[128:131], v5, s[40:43], s84 offen offset:0 sc1
    buffer_load_dwordx4 v[132:135], v5, s[40:43], s84 offen offset:512 sc1
L_tg_0:
    s_or_b32 vcc_lo, s25, s29
    s_or_b32 vcc_hi, s33, s37
    s_andn2_b64 exec, vcc, s[90:91]
    s_cbranch_execz L_tg_1
    s_or_b64 s[90:91], s[90:91], vcc
    buffer_load_dwordx4 v[220:223], v2, s[40:43], s81 offen offset:0 sc1
    buffer_load_dwordx4 v[224:227], v2, s[40:43], s81 offen offset:512 sc1
    buffer_load_dwordx4 v[136:139], v6, s[40:43], s85 offen offset:0 sc1
    buffer_load_dwordx4 v[140:143], v6, s[40:43], s85 offen offset:512 sc1
L_tg_1:
    s_or_b32 vcc_lo, s26, s30
    s_or_b32 vcc_hi, s34, s38
    s_andn2_b64 exec, vcc, s[72:73]
    s_cbranch_execz L_tg_2
    s_or_b64 s[72:73], s[72:73], vcc
    buffer_load_dwordx4 v[228:231], v3, s[40:43], s82 offen offset:0 sc1
    buffer_load_dwordx4 v[232:235], v3, s[40:43], s82 offen offset:512 sc1
    buffer_load_dwordx4 v[80:83], v7, s[40:43], s86 offen offset:0 sc1
    buffer_load_dwordx4 v[84:87], v7, s[40:43], s86 offen offset:512 sc1
L_tg_2:
    s_or_b32 vcc_lo, s27, s31
    s_or_b32 vcc_hi, s35, s39
    s_andn2_b64 exec, vcc, s[74:75]
    s_cbranch_execz L_tg_3
    s_or_b64 s[74:75], s[74:75], vcc
    buffer_load_dwordx4 v[236:239], v4, s[40:43], s83 offen offset:0 sc1
    buffer_load_dwordx4 v[240:243], v4, s[40:43], s83 offen offset:512 sc1
    buffer_load_dwordx4 v[244:247], v8, s[40:43], s87 offen offset:0 sc1
    buffer_load_dwordx4 v[248:251], v8, s[40:43], s87 offen offset:512 sc1
L_tg_3:
    s_mov_b64 exec, -1
    s_and_b64 vcc, s[88:89], s[90:91]
    s_and_b64 vcc, vcc, s[72:73]
    s_and_b64 vcc, vcc, s[74:75]
    s_cmp_eq_u64 vcc, -1
    s_cbranch_scc1 L_gathered
    s_sub_u32 s7, s7, 1
    s_cmp_lg_u32 s7, 0
    s_cbranch_scc1 L_gather
L_gathered:
    s_waitcnt vmcnt(0)
    v_mfma_f32_16x16x32_bf16 v[44:47], v[28:31], v[212:215], 0
    v_mfma_f32_16x16x32_bf16 v[44:47], v[32:35], v[216:219], v[44:47]
    v_mfma_f32_16x16x32_bf16 v[44:47], v[28:31], v[220:223], v[44:47]
    v_mfma_f32_16x16x32_bf16 v[44:47], v[32:35], v[224:227], v[44:47]
    s_nop 2
    v_mfma_f32_16x16x32_bf16 v[48:51], v[28:31], v[228:231], 0
    s_nop 1
    v_mfma_f32_16x16x32_bf16 v[48:51], v[32:35], v[232:235], v[48:51]
    v_mfma_f32_16x16x32_bf16 v[48:51], v[28:31], v[236:239], v[48:51]
    v_cvt_pk_bf16_f32 v44, v44, v45
    v_cvt_pk_bf16_f32 v45, v46, v47
    v_mfma_f32_16x16x32_bf16 v[48:51], v[32:35], v[240:243], v[48:51]
    ds_write_b64 v72, v[44:45] offset:0
    v_mfma_f32_16x16x32_bf16 v[52:55], v[28:31], v[128:131], 0
    s_nop 2
    v_mfma_f32_16x16x32_bf16 v[52:55], v[32:35], v[132:135], v[52:55]
    s_nop 0
    v_mfma_f32_16x16x32_bf16 v[52:55], v[28:31], v[136:139], v[52:55]
    v_cvt_pk_bf16_f32 v48, v48, v49
    v_cvt_pk_bf16_f32 v49, v50, v51
    v_mfma_f32_16x16x32_bf16 v[52:55], v[32:35], v[140:143], v[52:55]
    ds_write_b64 v72, v[48:49] offset:2304
    v_mfma_f32_16x16x32_bf16 v[52:55], v[28:31], v[80:83], v[52:55]
    v_mfma_f32_16x16x32_bf16 v[52:55], v[32:35], v[84:87], v[52:55]
    v_mfma_f32_16x16x32_bf16 v[52:55], v[28:31], v[244:247], v[52:55]
    v_mfma_f32_16x16x32_bf16 v[52:55], v[32:35], v[248:251], v[52:55]
    s_nop 7
    v_cvt_pk_bf16_f32 v52, v52, v53
    v_cvt_pk_bf16_f32 v53, v54, v55
    ds_write_b64 v72, v[52:53] offset:4608
    s_waitcnt lgkmcnt(0)
    s_barrier
    ds_read_b128 v[44:47], v73 offset:0
    ds_read_b128 v[48:51], v73 offset:4608
    s_waitcnt lgkmcnt(1)
    buffer_store_dwordx4 v[44:47], v74, s[12:15], s55 offen sc1
    s_waitcnt lgkmcnt(0)
    buffer_store_dwordx4 v[48:51], v75, s[12:15], s55 offen sc1
L_end:
    s_endpgm
L_spin_rdy:
    s_mov_b32 s7, 400000
L_again_rdy:
    buffer_load_dwordx2 v[24:25], off, s[16:19], s9 sc1
    s_waitcnt vmcnt(0)
    v_cmp_ne_u16 vcc, 0xffff, v24
    s_nop 1
    s_cbranch_vccz L_back_rdy
    s_sub_u32 s7, s7, 1
    s_cmp_lg_u32 s7, 0
    s_cbranch_scc1 L_again_rdy
    s_branch L_back_rdy
L_far_p1:
    s_mov_b32 s7, 400000
L_again_p1:
    s_load_dword s60, s[40:41], s61 glc
    s_waitcnt lgkmcnt(0)
    s_cmp_ge_u32 s60, 1
    s_cbranch_scc1 L_near_p1
    s_sub_u32 s7, s7, 1
    s_cmp_lg_u32 s7, 0
    s_cbranch_scc1 L_again_p1
    s_branch L_near_p1
L_far_p2:
    s_mov_b32 s7, 400000
L_again_p2:
    s_load_dword s60, s[40:41], s61 glc
    s_waitcnt lgkmcnt(0)
    s_cmp_ge_u32 s60, 2
    s_cbranch_scc1 L_near_p2
    s_sub_u32 s7, s7, 1
    s_cmp_lg_u32 s7, 0
    s_cbranch_scc1 L_again_p2
    s_branch L_near_p2
L_fallback:
    s_waitcnt vmcnt(0) lgkmcnt(0)
    s_barrier
    v_mov_b32 v76, 0xff800000
    v_mov_b32 v80, 0xff800000
    v_mov_b32 v84, 0xff800000
    s_mov_b32 s4, s80
    s_mov_b32 s5, 0
L_fb_loop:
    s_add_u32 m0, s88, 96768
    s_nop 0
    buffer_load_dwordx4 v9, s[24:27], s4 offen offset:0 lds
    s_add_u32 m0, s88, 98592
    s_nop 0
    buffer_load_dwordx4 v9, s[24:27], s4 offen offset:256 lds
    s_add_u32 m0, s88, 100416
    s_nop 0
    buffer_load_dwordx4 v9, s[24:27], s4 offen offset:512 lds
    s_add_u32 m0, s88, 102240
    s_nop 0
    buffer_load_dwordx4 v9, s[24:27], s4 offen offset:768 lds
    s_waitcnt vmcnt(0)
    s_barrier
    ds_read_b128 a[96:99], v1 offset:0
    ds_read_b128 a[100:103], v1 offset:64
    ds_read_b128 a[104:107], v2 offset:0
    ds_read_b128 a[108:111], v2 offset:64
    ds_read_b128 a[112:115], v1 offset:256
    ds_read_b128 a[116:119], v1 offset:320
    ds_read_b128 a[120:123], v2 offset:256
    ds_read_b128 a[124:127], v2 offset:320
    ds_read_b128 a[128:131], v3 offset:0
    ds_read_b128 a[132:135], v3 offset:64
    ds_read_b128 a[136:139], v4 offset:0
    ds_read_b128 a[140:143], v4 offset:64
    ds_read_b128 a[144:147], v3 offset:256
    ds_read_b128 a[148:151], v3 offset:320
    ds_read_b128 a[152:155], v4 offset:256
    ds_read_b128 a[156:159], v4 offset:320
    s_waitcnt lgkmcnt(0)
    s_barrier
    v_mfma_f32_16x16x32_bf16 v[88:91], a[96:99], v[28:31], 0
    v_mfma_f32_16x16x32_bf16 v[88:91], a[100:103], v[32:35], v[88:91]
    v_mfma_f32_16x16x32_bf16 v[88:91], a[104:107], v[36:39], v[88:91]
    v_mfma_f32_16x16x32_bf16 v[88:91], a[108:111], v[40:43], v[88:91]
    v_mfma_f32_16x16x32_bf16 v[92:95], a[112:115], v[28:31], 0
    v_mfma_f32_16x16x32_bf16 v[92:95], a[116:119], v[32:35], v[92:95]
    v_mfma_f32_16x16x32_bf16 v[92:95], a[120:123], v[36:39], v[92:95]
    v_mfma_f32_16x16x32_bf16 v[92:95], a[124:127], v[40:43], v[92:95]
    v_mfma_f32_16x16x32_bf16 v[96:99], a[96:99], v[44:47], 0
    v_mfma_f32_16x16x32_bf16 v[96:99], a[100:103], v[48:51], v[96:99]
    v_mfma_f32_16x16x32_bf16 v[96:99], a[104:107], v[52:55], v[96:99]
    v_mfma_f32_16x16x32_bf16 v[96:99], a[108:111], v[56:59], v[96:99]
    v_mfma_f32_16x16x32_bf16 v[100:103], a[112:115], v[44:47], 0
    v_mfma_f32_16x16x32_bf16 v[100:103], a[116:119], v[48:51], v[100:103]
    v_mfma_f32_16x16x32_bf16 v[100:103], a[120:123], v[52:55], v[100:103]
    v_mfma_f32_16x16x32_bf16 v[100:103], a[124:127], v[56:59], v[100:103]
    v_mfma_f32_16x16x32_bf16 v[104:107], a[96:99], v[60:63], 0
    v_mfma_f32_16x16x32_bf16 v[104:107], a[100:103], v[64:67], v[104:107]
    v_mfma_f32_16x16x32_bf16 v[104:107], a[104:107], v[68:71], v[104:107]
    v_mfma_f32_16x16x32_bf16 v[104:107], a[108:111], v[72:75], v[104:107]
    v_mfma_f32_16x16x32_bf16 v[108:111], a[112:115], v[60:63], 0
    v_mfma_f32_16x16x32_bf16 v[108:111], a[116:119], v[64:67], v[108:111]
    v_mfma_f32_16x16x32_bf16 v[108:111], a[120:123], v[68:71], v[108:111]
    v_mfma_f32_16x16x32_bf16 v[108:111], a[124:127], v[72:75], v[108:111]
    s_nop 7
    s_nop 1
    v_max3_f32 v76, v76, v88, v89
    v_max3_f32 v76, v76, v90, v91
    v_max3_f32 v76, v76, v92, v93
    v_max3_f32 v76, v76, v94, v95
    v_max3_f32 v80, v80, v96, v97
    v_max3_f32 v80, v80, v98, v99
    v_max3_f32 v80, v80, v100, v101
    v_max3_f32 v80, v80, v102, v103
    v_max3_f32 v84, v84, v104, v105
    v_max3_f32 v84, v84, v106, v107
    v_max3_f32 v84, v84, v108, v109
    v_max3_f32 v84, v84, v110, v111
    s_nop 1
    v_mfma_f32_16x16x32_bf16 v[88:91], a[128:131], v[28:31], 0
    v_mfma_f32_16x16x32_bf16 v[88:91], a[132:135], v[32:35], v[88:91]
    v_mfma_f32_16x16x32_bf16 v[88:91], a[136:139], v[36:39], v[88:91]
    v_mfma_f32_16x16x32_bf16 v[88:91], a[140:143], v[40:43], v[88:91]
    v_mfma_f32_16x16x32_bf16 v[92:95], a[144:147], v[28:31], 0
    v_mfma_f32_16x16x32_bf16 v[92:95], a[148:151], v[32:35], v[92:95]
    v_mfma_f32_16x16x32_bf16 v[92:95], a[152:155], v[36:39], v[92:95]
    v_mfma_f32_16x16x32_bf16 v[92:95], a[156:159], v[40:43], v[92:95]
    v_mfma_f32_16x16x32_bf16 v[96:99], a[128:131], v[44:47], 0
    v_mfma_f32_16x16x32_bf16 v[96:99], a[132:135], v[48:51], v[96:99]
    v_mfma_f32_16x16x32_bf16 v[96:99], a[136:139], v[52:55], v[96:99]
    v_mfma_f32_16x16x32_bf16 v[96:99], a[140:143], v[56:59], v[96:99]
    v_mfma_f32_16x16x32_bf16 v[100:103], a[144:147], v[44:47], 0
    v_mfma_f32_16x16x32_bf16 v[100:103], a[148:151], v[48:51], v[100:103]
    v_mfma_f32_16x16x32_bf16 v[100:103], a[152:155], v[52:55], v[100:103]
    v_mfma_f32_16x16x32_bf16 v[100:103], a[156:159], v[56:59], v[100:103]
    v_mfma_f32_16x16x32_bf16 v[104:107], a[128:131], v[60:63], 0
    v_mfma_f32_16x16x32_bf16 v[104:107], a[132:135], v[64:67], v[104:107]
    v_mfma_f32_16x16x32_bf16 v[104:107], a[136:139], v[68:71], v[104:107]
    v_mfma_f32_16x16x32_bf16 v[104:107], a[140:143], v[72:75], v[104:107]
    v_mfma_f32_16x16x32_bf16 v[108:111], a[144:147], v[60:63], 0
    v_mfma_f32_16x16x32_bf16 v[108:111], a[148:151], v[64:67], v[108:111]
    v_mfma_f32_16x16x32_bf16 v[108:111], a[152:155], v[68:71], v[108:111]
    v_mfma_f32_16x16x32_bf16 v[108:111], a[156:159], v[72:75], v[108:111]
    s_nop 7
    s_nop 1
    v_max3_f32 v76, v76, v88, v89
    v_max3_f32 v76, v76, v90, v91
    v_max3_f32 v76, v76, v92, v93
    v_max3_f32 v76, v76, v94, v95
    v_max3_f32 v80, v80, v96, v97
    v_max3_f32 v80, v80, v98, v99
    v_max3_f32 v80, v80, v100, v101
    v_max3_f32 v80, v80, v102, v103
    v_max3_f32 v84, v84, v104, v105
    v_max3_f32 v84, v84, v106, v107
    v_max3_f32 v84, v84, v108, v109
    v_max3_f32 v84, v84, v110, v111
    s_nop 1
    s_add_u32 s4, s4, 16384
    s_add_u32 s5, s5, 1
    s_cmp_lt_u32 s5, 8
    s_cbranch_scc1 L_fb_loop
    v_mov_b32 v77, v76
    s_nop 1
    v_permlane16_swap_b32 v76, v77
    s_nop 1
    v_max_f32 v76, v76, v77
    v_mov_b32 v77, v76
    s_nop 1
    v_permlane32_swap_b32 v76, v77
    s_nop 1
    v_max_f32 v76, v76, v77
    v_sub_f32 v76, 0, v76
    v_mov_b32 v77, v76
    v_mov_b32 v78, v76
    v_mov_b32 v79, v76
    v_mov_b32 v81, v80
    s_nop 1
    v_permlane16_swap_b32 v80, v81
    s_nop 1
    v_max_f32 v80, v80, v81
    v_mov_b32 v81, v80
    s_nop 1
    v_permlane32_swap_b32 v80, v81
    s_nop 1
    v_max_f32 v80, v80, v81
    v_sub_f32 v80, 0, v80
    v_mov_b32 v81, v80
    v_mov_b32 v82, v80
    v_mov_b32 v83, v80
    v_mov_b32 v85, v84
    s_nop 1
    v_permlane16_swap_b32 v84, v85
    s_nop 1
    v_max_f32 v84, v84, v85
    v_mov_b32 v85, v84
    s_nop 1
    v_permlane32_swap_b32 v84, v85
    s_nop 1
    v_max_f32 v84, v84, v85
    v_sub_f32 v84, 0, v84
    v_mov_b32 v85, v84
    v_mov_b32 v86, v84
    v_mov_b32 v87, v84
    s_mov_b32 s94, -1
    s_branch L_restart
.p2align 8
.fill 3072, 4, 0xbf800000
.section .rodata,"a"
.p2align 6
.amdhsa_kernel standalone__gqa_block_cached__near_ridge_kernel
  .amdhsa_next_free_vgpr 512
  .amdhsa_next_free_sgpr 102
  .amdhsa_accum_offset 256
  .amdhsa_group_segment_fixed_size 0
  .amdhsa_kernarg_size 64
  .amdhsa_user_sgpr_count 2
  .amdhsa_user_sgpr_kernarg_segment_ptr 1
  .amdhsa_system_sgpr_workgroup_id_x 1
.end_amdhsa_kernel
```
